```python
import torch

def _softmax(x, axis=-1):
    return torch.softmax(x, dim=axis)
def _gelu(x):
    return torch.nn.functional.gelu(x, approximate="tanh")
def _silu(x):
    return torch.nn.functional.silu(x)
def _sigmoid(x):
    return torch.sigmoid(x)
def _layernorm(x, axis=-1, eps=1e-5):
    m = x.mean(dim=axis, keepdim=True)
    v = x.var(dim=axis, keepdim=True, unbiased=False)
    return (x - m) / torch.sqrt(v + eps)
def _scatter_add(tgt, idx, src, axis=0):
    return tgt.clone().index_add_(axis, idx, src)
def _segment_sum(src, seg, n):
    out = torch.zeros((n,) + src.shape[1:], dtype=src.dtype)
    return out.index_add_(0, seg, src)
def _pad(x, pw):
    flat = tuple(v for pair in reversed(pw) for v in pair)
    return torch.nn.functional.pad(x, flat)

kernel_name = 'recurrent_scan__ssm_conv_h3__dense_activation_squared_relu__prompt'

def setup_inputs():

    _w = (lambda a: (lambda t: t.to(torch.bfloat16) if t.is_floating_point() else t)(torch.as_tensor(a)))
    def _A_setup():
        B, S, D = 1, 2048, 640
        ks = 4
        return {
            "q": _w((lambda *s: torch.randn(*s, dtype=torch.bfloat16) * 0.05)(B, S, D)),
            "k": _w((lambda *s: torch.randn(*s, dtype=torch.bfloat16) * 0.2)(B, S, D)),
            "v": _w((lambda *s: torch.randn(*s, dtype=torch.bfloat16) * 0.2)(B, S, D)),
            "shift_k": _w((lambda *s: torch.randn(*s, dtype=torch.bfloat16) * 0.2)(D, ks) * 0.5),
            "ssm_k": _w((lambda *s: torch.randn(*s, dtype=torch.bfloat16) * 0.2)(D, S) * (1.0 / S ** 0.5)),
            "ssm_D": _w((lambda *s: torch.randn(*s, dtype=torch.bfloat16) * 0.2)(D)),
        }
    _A_in = _A_setup()

    def _B_setup():
        B, S, D, F = 1, 2048, 640, 1536
        return {
            "x": _w((lambda *s: torch.randn(*s, dtype=torch.bfloat16) * 0.05)(B, S, D)),
            "w1": _w((lambda *s: torch.randn(*s, dtype=torch.bfloat16) * 0.1)(D, F)),
            "b1": _w((lambda *s: torch.randn(*s, dtype=torch.bfloat16) * 0.8)(F)),
            "w2": _w((lambda *s: torch.randn(*s, dtype=torch.bfloat16) * 0.1)(F, D)),
            "b2": _w((lambda *s: torch.randn(*s, dtype=torch.bfloat16) * 6.4)(D)),
        }
    _B_in = _B_setup()

    return {
        "A_q": _A_in["q"],
        "A_k": _A_in["k"],
        "A_v": _A_in["v"],
        "A_shift_k": _A_in["shift_k"],
        "A_ssm_k": _A_in["ssm_k"],
        "A_ssm_D": _A_in["ssm_D"],
        "B_x": _B_in["x"],
        "B_w1": _B_in["w1"],
        "B_b1": _B_in["b1"],
        "B_w2": _B_in["w2"],
        "B_b2": _B_in["b2"],
    }

def reference(A_q, A_k, A_v, A_shift_k, A_ssm_k, A_ssm_D, B_x, B_w1, B_b1, B_w2, B_b2):
    def _A_ref(q, k, v, shift_k, ssm_k, ssm_D):
        B, S, D = q.shape
        ks = shift_k.shape[-1]
        k_pad = _pad(k, ((0, 0), (ks - 1, 0), (0, 0)))
        k_shift = torch.zeros_like(k)
        for t in range(ks):
            k_shift = k_shift + k_pad[:, t:t + S, :] * shift_k[:, ks - 1 - t][None, None, :]
        kv = k_shift * v
        L = 2 * S
        kv_pad = _pad(kv, ((0, 0), (0, S), (0, 0)))
        kf_pad = _pad(ssm_k, ((0, 0), (0, S)))
        kv_f = (lambda x, axes=(-2,-1): torch.fft.rfft2(x.float(), dim=axes))(kv_pad[:, None, :, :], axes=(1, 2))
        kf_f = (lambda x, axes=(-2,-1): torch.fft.rfft2(x.float(), dim=axes))(kf_pad[:, None, :], axes=(1, 2))
        kf_f = (lambda x, *d: x.permute(*d))(kf_f, 1, 2, 0)
        y_f = kv_f * kf_f[None, :, :, :]
        y = (lambda x, s, axes=(-2,-1): torch.fft.irfft2(x, s=s, dim=axes).to(torch.bfloat16))(y_f, (1, L), axes=(1, 2))[:, 0, :S, :]
        y = y + kv * ssm_D[None, None, :]
        return q * y

    def _B_ref(x, w1, b1, w2, b2):
        h = torch.einsum("bsd,df->bsf", x, w1) + b1
        zero = torch.zeros_like(h)
        r = torch.where(h > zero, h, zero)
        h = r * r
        out = torch.einsum("bsf,fd->bsd", h, w2) + b2
        return out

    x = A_q
    xn = _layernorm(x, axis=-1)
    s = _A_ref(xn, A_k, A_v, A_shift_k, A_ssm_k, A_ssm_D)
    g = _silu(_B_ref(xn, B_w1, B_b1, B_w2, B_b2))
    return x + s * g
```

```asm
; @launch grid=(256,1,1) block=(512,1,1) lds=158976
.amdgcn_target "amdgcn-amd-amdhsa--gfx950"
.text
.globl recurrent_scan__ssm_conv_h3__dense_activation_squared_relu__prompt_kernel
.p2align 8
.type recurrent_scan__ssm_conv_h3__dense_activation_squared_relu__prompt_kernel,@function
recurrent_scan__ssm_conv_h3__dense_activation_squared_relu__prompt_kernel:
    s_cmp_ge_u32 s2, 256
    s_cbranch_scc1 recurrent_scan__ssm_conv_h3__dense_activation_squared_relu__prompt_kernel_end
    s_load_dwordx16 s[72:87], s[0:1], 0
    s_load_dwordx8 s[88:95], s[0:1], 64
    s_load_dwordx4 s[96:99], s[0:1], 96
    v_lshrrev_b32 v1, 6, v0
    s_nop 0
    v_readfirstlane_b32 s29, v1
    s_nop 3
    s_cmp_lg_u32 s29, 7
    s_cbranch_scc1 zs_1
    v_and_b32 v3, 63, v0
    v_lshlrev_b32 v3, 2, v3
    v_add_u32 v3, 156672, v3
    v_mov_b32 v4, 0
    ds_write_b32 v3, v4
    s_waitcnt lgkmcnt(0)
zs_1:
    s_cmp_ge_u32 s2, 192
    s_cbranch_scc1 L_helper
    s_and_b32 s20, s2, 7
    s_lshr_b32 s21, s2, 3
    s_lshr_b32 s22, s20, 1
    s_lshl_b32 s22, s22, 2
    s_and_b32 s23, s21, 3
    s_add_u32 s30, s22, s23
    s_and_b32 s22, s20, 1
    s_mul_i32 s22, s22, 6
    s_lshr_b32 s23, s21, 2
    s_add_u32 s31, s22, s23
    s_cmp_ge_u32 s29, 4
    s_cbranch_scc1 L_g1prod
    s_mov_b32 s22, s30
    s_mov_b32 s23, s31
    s_and_b32 s34, s29, 1
    s_lshr_b32 s35, s29, 1
    v_and_b32 v2, 63, v0
    v_lshrrev_b32 v3, 4, v2
    v_and_b32 v4, 15, v2
    v_lshrrev_b32 v5, 2, v4
    v_and_b32 v7, 1, v3
    v_lshlrev_b32 v8, 1, v7
    v_bfe_u32 v7, v4, 1, 1
    v_add_u32 v8, v8, v7
    v_lshlrev_b32 v8, 4, v8
    v_and_b32 v7, 1, v4
    v_lshl_add_u32 v8, v7, 3, v8
    v_lshrrev_b32 v7, 1, v3
    v_lshl_add_u32 v9, v7, 3, v5
    v_lshl_add_u32 v8, v9, 8, v8
    v_add_u32 v8, 16384, v8
    s_lshl_b32 s24, s34, 1
    s_add_u32 s25, s24, 0
    v_xor_b32 v6, s25, v5
    v_lshl_add_u32 v10, v6, 6, v8
    v_add_u32 v12, 0x10000, v10
    s_add_u32 s25, s24, 1
    v_xor_b32 v6, s25, v5
    v_lshl_add_u32 v11, v6, 6, v8
    v_add_u32 v13, 0x10000, v11
    v_and_b32 v3, 31, v2
    s_lshl_b32 s24, s35, 6
    v_add_u32 v3, s24, v3
    v_lshrrev_b32 v4, 5, v2
    v_bfe_u32 v5, v3, 1, 3
    v_xor_b32 v5, v5, v4
    v_lshlrev_b32 v5, 4, v5
    v_lshl_add_u32 v14, v3, 7, v5
    v_xor_b32 v15, 32, v14
    v_xor_b32 v16, 64, v14
    v_xor_b32 v17, 96, v14
    v_add_u32 v18, 0x10000, v14
    v_add_u32 v19, 0x10000, v15
    v_add_u32 v20, 0x10000, v16
    v_add_u32 v21, 0x10000, v17
    v_bfe_u32 v3, v2, 4, 1
    v_lshlrev_b32 v3, 10, v3
    v_and_b32 v4, 15, v2
    v_lshl_add_u32 v3, v4, 4, v3
    v_lshrrev_b32 v4, 5, v2
    v_lshl_add_u32 v22, v4, 8, v3
    v_lshlrev_b32 v23, 4, v2
    v_add_u32 v23, 131072, v23
    s_lshl_b32 s24, s34, 11
    v_add_u32 v24, s24, v23
    s_lshl_b32 s24, s35, 11
    v_add_u32 v25, s24, v23
    s_lshl_b32 s24, s30, 1
    s_add_u32 s24, s24, s35
    s_mul_i32 s33, s24, 24
    s_mul_i32 s24, s24, 48
    s_lshl_b32 s25, s31, 2
    s_add_u32 s24, s24, s25
    s_lshl_b32 s25, s34, 1
    s_add_u32 s24, s24, s25
    s_lshl_b32 s36, s24, 12
    s_add_u32 s37, s36, 4096
    s_lshl_b32 s25, s31, 1
    s_add_u32 s33, s33, s25
    s_add_u32 s33, s33, s34
    s_lshl_b32 s33, s33, 7
    s_add_u32 s33, s33, 169984
    s_waitcnt lgkmcnt(0)
    s_mov_b64 s[16:17], s[98:99]
    s_and_b32 s17, s17, 0xffff
    s_mov_b32 s18, 6291456
    s_mov_b32 s19, 0x00020000
    v_lshrrev_b32 v3, 4, v2
    v_and_b32 v4, 15, v2
    v_lshrrev_b32 v5, 1, v3
    v_lshlrev_b32 v5, 4, v5
    v_and_b32 v6, 1, v3
    v_lshl_add_u32 v5, v6, 2, v5
    v_lshrrev_b32 v6, 2, v4
    v_add_u32 v5, v5, v6
    v_mul_u32_u24 v5, 320, v5
    v_and_b32 v6, 3, v4
    v_lshl_add_u32 v5, v6, 3, v5
    s_mul_i32 s24, s35, 160
    s_mul_i32 s25, s34, 96
    s_add_u32 s24, s24, s25
    s_add_u32 s24, s24, 139264
    v_add_u32 v28, s24, v5
    v_lshlrev_b32 v29, 4, v2
    s_and_b32 s38, s2, 3
    s_lshl_b32 s38, s38, 1
    s_add_u32 s38, s38, s35
    s_mul_i32 s38, s38, 48
    s_lshr_b32 s39, s2, 2
    s_add_u32 s38, s38, s39
    s_mul_i32 s38, s38, 5120
    s_mul_i32 s39, s34, 3072
    s_add_u32 s38, s38, s39
    s_lshl_b32 s39, s34, 10
    s_sub_u32 s39, s38, s39
    s_add_u32 s39, s39, 2048
    s_cmp_eq_u32 s34, 0
    s_cselect_b32 s39, s39, 0x7ffff000
    s_mov_b64 s[8:9], s[98:99]
    s_add_u32 s8, s8, 6291456
    s_addc_u32 s9, s9, 0
    s_and_b32 s9, s9, 0xffff
    s_mov_b32 s10, 1966080
    s_mov_b32 s11, 0x00020000
    s_waitcnt lgkmcnt(0)
    s_add_u32 s50, s98, 13615104
    s_addc_u32 s51, s99, 0
    s_mov_b32 s48, 325632
    s_load_dword s28, s[50:51], s48
    s_mov_b64 s[40:41], s[98:99]
    s_add_u32 s40, s40, 13615104
    s_addc_u32 s41, s41, 0
    s_and_b32 s41, s41, 0xffff
    s_mov_b32 s42, 325760
    s_mov_b32 s43, 0x00020000
    s_mov_b64 s[44:45], s[96:97]
    s_and_b32 s45, s45, 0xffff
    s_mov_b32 s46, 256
    s_mov_b32 s47, 0x00020000
    s_waitcnt lgkmcnt(0)
    s_add_u32 s28, s28, 1
    v_and_b32 v218, 31, v2
    v_lshrrev_b32 v219, 5, v2
    s_and_b32 s24, s2, 3
    s_lshl_b32 s24, s24, 1
    v_add_u32 v219, s24, v219
    v_lshrrev_b32 v221, 3, v218
    v_lshlrev_b32 v221, 1, v221
    v_lshrrev_b32 v220, 2, v219
    v_add_u32 v221, v221, v220
    v_and_b32 v220, 3, v219
    v_lshlrev_b32 v220, 6, v220
    v_add_u32 v221, v221, v220
    v_and_b32 v220, 7, v218
    v_lshl_add_u32 v221, v220, 3, v221
    v_lshlrev_b32 v221, 9, v221
    s_lshr_b32 s24, s2, 2
    s_lshl_b32 s24, s24, 2
    s_add_u32 s24, s24, 194816
    v_add_u32 v221, s24, v221
    s_cmp_lt_u32 s30, 10
    s_cselect_b32 s32, 0, 0
    s_cmp_eq_u32 s35, 0
    s_cselect_b32 s32, s32, 0
    s_waitcnt lgkmcnt(0)
    s_barrier
    ds_read_b64_tr_b16 v[128:129], v10 offset:0
    ds_read_b64_tr_b16 v[130:131], v10 offset:1024
    ds_read_b64_tr_b16 v[132:133], v11 offset:0
    ds_read_b64_tr_b16 v[134:135], v11 offset:1024
    ds_read_b128 v[136:139], v14 offset:0
    ds_read_b128 v[140:143], v14 offset:4096
    ds_read_b64_tr_b16 v[144:145], v10 offset:4096
    ds_read_b64_tr_b16 v[146:147], v10 offset:5120
    ds_read_b64_tr_b16 v[148:149], v11 offset:4096
    ds_read_b64_tr_b16 v[150:151], v11 offset:5120
    ds_read_b128 v[152:155], v15 offset:0
    ds_read_b128 v[156:159], v15 offset:4096
    s_waitcnt lgkmcnt(6)
    v_mfma_f32_32x32x16_bf16 v[64:79], v[128:131], v[136:139], 0
    ds_read_b64_tr_b16 v[160:161], v10 offset:8192
    ds_read_b64_tr_b16 v[162:163], v10 offset:9216
    v_mfma_f32_32x32x16_bf16 v[80:95], v[128:131], v[140:143], 0
    ds_read_b64_tr_b16 v[164:165], v11 offset:8192
    ds_read_b64_tr_b16 v[166:167], v11 offset:9216
    v_mfma_f32_32x32x16_bf16 v[96:111], v[132:135], v[136:139], 0
    ds_read_b128 v[168:171], v16 offset:0
    ds_read_b128 v[172:175], v16 offset:4096
    v_mfma_f32_32x32x16_bf16 v[112:127], v[132:135], v[140:143], 0
    s_waitcnt lgkmcnt(6)
    v_mfma_f32_32x32x16_bf16 v[64:79], v[144:147], v[152:155], v[64:79]
    ds_read_b64_tr_b16 v[128:129], v10 offset:12288
    ds_read_b64_tr_b16 v[130:131], v10 offset:13312
    v_mfma_f32_32x32x16_bf16 v[80:95], v[144:147], v[156:159], v[80:95]
    ds_read_b64_tr_b16 v[132:133], v11 offset:12288
    ds_read_b64_tr_b16 v[134:135], v11 offset:13312
    v_mfma_f32_32x32x16_bf16 v[96:111], v[148:151], v[152:155], v[96:111]
    ds_read_b128 v[136:139], v17 offset:0
    ds_read_b128 v[140:143], v17 offset:4096
    v_mfma_f32_32x32x16_bf16 v[112:127], v[148:151], v[156:159], v[112:127]
    s_waitcnt lgkmcnt(0)
    s_barrier
    v_mfma_f32_32x32x16_bf16 v[64:79], v[160:163], v[168:171], v[64:79]
    ds_read_b64_tr_b16 v[144:145], v10 offset:32768
    ds_read_b64_tr_b16 v[146:147], v10 offset:33792
    v_mfma_f32_32x32x16_bf16 v[80:95], v[160:163], v[172:175], v[80:95]
    ds_read_b64_tr_b16 v[148:149], v11 offset:32768
    ds_read_b64_tr_b16 v[150:151], v11 offset:33792
    v_mfma_f32_32x32x16_bf16 v[96:111], v[164:167], v[168:171], v[96:111]
    ds_read_b128 v[152:155], v14 offset:32768
    ds_read_b128 v[156:159], v14 offset:36864
    v_mfma_f32_32x32x16_bf16 v[112:127], v[164:167], v[172:175], v[112:127]
    s_waitcnt lgkmcnt(6)
    v_mfma_f32_32x32x16_bf16 v[64:79], v[128:131], v[136:139], v[64:79]
    ds_read_b64_tr_b16 v[160:161], v10 offset:36864
    ds_read_b64_tr_b16 v[162:163], v10 offset:37888
    v_mfma_f32_32x32x16_bf16 v[80:95], v[128:131], v[140:143], v[80:95]
    ds_read_b64_tr_b16 v[164:165], v11 offset:36864
    ds_read_b64_tr_b16 v[166:167], v11 offset:37888
    v_mfma_f32_32x32x16_bf16 v[96:111], v[132:135], v[136:139], v[96:111]
    ds_read_b128 v[168:171], v15 offset:32768
    ds_read_b128 v[172:175], v15 offset:36864
    v_mfma_f32_32x32x16_bf16 v[112:127], v[132:135], v[140:143], v[112:127]
    s_waitcnt lgkmcnt(6)
    v_mfma_f32_32x32x16_bf16 v[64:79], v[144:147], v[152:155], v[64:79]
    ds_read_b64_tr_b16 v[128:129], v10 offset:40960
    ds_read_b64_tr_b16 v[130:131], v10 offset:41984
    v_mfma_f32_32x32x16_bf16 v[80:95], v[144:147], v[156:159], v[80:95]
    ds_read_b64_tr_b16 v[132:133], v11 offset:40960
    ds_read_b64_tr_b16 v[134:135], v11 offset:41984
    v_mfma_f32_32x32x16_bf16 v[96:111], v[148:151], v[152:155], v[96:111]
    ds_read_b128 v[136:139], v16 offset:32768
    ds_read_b128 v[140:143], v16 offset:36864
    v_mfma_f32_32x32x16_bf16 v[112:127], v[148:151], v[156:159], v[112:127]
    s_waitcnt lgkmcnt(6)
    v_mfma_f32_32x32x16_bf16 v[64:79], v[160:163], v[168:171], v[64:79]
    ds_read_b64_tr_b16 v[144:145], v10 offset:45056
    ds_read_b64_tr_b16 v[146:147], v10 offset:46080
    v_mfma_f32_32x32x16_bf16 v[80:95], v[160:163], v[172:175], v[80:95]
    ds_read_b64_tr_b16 v[148:149], v11 offset:45056
    ds_read_b64_tr_b16 v[150:151], v11 offset:46080
    v_mfma_f32_32x32x16_bf16 v[96:111], v[164:167], v[168:171], v[96:111]
    ds_read_b128 v[152:155], v17 offset:32768
    ds_read_b128 v[156:159], v17 offset:36864
    v_mfma_f32_32x32x16_bf16 v[112:127], v[164:167], v[172:175], v[112:127]
    s_waitcnt lgkmcnt(0)
    s_barrier
    v_mfma_f32_32x32x16_bf16 v[64:79], v[128:131], v[136:139], v[64:79]
    ds_read_b64_tr_b16 v[160:161], v12 offset:0
    ds_read_b64_tr_b16 v[162:163], v12 offset:1024
    v_mfma_f32_32x32x16_bf16 v[80:95], v[128:131], v[140:143], v[80:95]
    ds_read_b64_tr_b16 v[164:165], v13 offset:0
    ds_read_b64_tr_b16 v[166:167], v13 offset:1024
    v_mfma_f32_32x32x16_bf16 v[96:111], v[132:135], v[136:139], v[96:111]
    ds_read_b128 v[168:171], v18 offset:0
    ds_read_b128 v[172:175], v18 offset:4096
    v_mfma_f32_32x32x16_bf16 v[112:127], v[132:135], v[140:143], v[112:127]
    s_waitcnt lgkmcnt(6)
    v_mfma_f32_32x32x16_bf16 v[64:79], v[144:147], v[152:155], v[64:79]
    ds_read_b64_tr_b16 v[128:129], v12 offset:4096
    ds_read_b64_tr_b16 v[130:131], v12 offset:5120
    v_mfma_f32_32x32x16_bf16 v[80:95], v[144:147], v[156:159], v[80:95]
    ds_read_b64_tr_b16 v[132:133], v13 offset:4096
    ds_read_b64_tr_b16 v[134:135], v13 offset:5120
    v_mfma_f32_32x32x16_bf16 v[96:111], v[148:151], v[152:155], v[96:111]
    ds_read_b128 v[136:139], v19 offset:0
    ds_read_b128 v[140:143], v19 offset:4096
    v_mfma_f32_32x32x16_bf16 v[112:127], v[148:151], v[156:159], v[112:127]
    s_waitcnt lgkmcnt(6)
    v_mfma_f32_32x32x16_bf16 v[64:79], v[160:163], v[168:171], v[64:79]
    ds_read_b64_tr_b16 v[144:145], v12 offset:8192
    ds_read_b64_tr_b16 v[146:147], v12 offset:9216
    v_mfma_f32_32x32x16_bf16 v[80:95], v[160:163], v[172:175], v[80:95]
    ds_read_b64_tr_b16 v[148:149], v13 offset:8192
    ds_read_b64_tr_b16 v[150:151], v13 offset:9216
    v_mfma_f32_32x32x16_bf16 v[96:111], v[164:167], v[168:171], v[96:111]
    ds_read_b128 v[152:155], v20 offset:0
    ds_read_b128 v[156:159], v20 offset:4096
    v_mfma_f32_32x32x16_bf16 v[112:127], v[164:167], v[172:175], v[112:127]
    s_waitcnt lgkmcnt(6)
    v_mfma_f32_32x32x16_bf16 v[64:79], v[128:131], v[136:139], v[64:79]
    ds_read_b64_tr_b16 v[160:161], v12 offset:12288
    ds_read_b64_tr_b16 v[162:163], v12 offset:13312
    v_mfma_f32_32x32x16_bf16 v[80:95], v[128:131], v[140:143], v[80:95]
    ds_read_b64_tr_b16 v[164:165], v13 offset:12288
    ds_read_b64_tr_b16 v[166:167], v13 offset:13312
    v_mfma_f32_32x32x16_bf16 v[96:111], v[132:135], v[136:139], v[96:111]
    ds_read_b128 v[168:171], v21 offset:0
    ds_read_b128 v[172:175], v21 offset:4096
    v_mfma_f32_32x32x16_bf16 v[112:127], v[132:135], v[140:143], v[112:127]
    s_waitcnt lgkmcnt(0)
    s_barrier
    v_mfma_f32_32x32x16_bf16 v[64:79], v[144:147], v[152:155], v[64:79]
    ds_read_b64_tr_b16 v[128:129], v12 offset:32768
    ds_read_b64_tr_b16 v[130:131], v12 offset:33792
    v_mfma_f32_32x32x16_bf16 v[80:95], v[144:147], v[156:159], v[80:95]
    ds_read_b64_tr_b16 v[132:133], v13 offset:32768
    ds_read_b64_tr_b16 v[134:135], v13 offset:33792
    v_mfma_f32_32x32x16_bf16 v[96:111], v[148:151], v[152:155], v[96:111]
    ds_read_b128 v[136:139], v18 offset:32768
    ds_read_b128 v[140:143], v18 offset:36864
    v_mfma_f32_32x32x16_bf16 v[112:127], v[148:151], v[156:159], v[112:127]
    s_waitcnt lgkmcnt(6)
    v_mfma_f32_32x32x16_bf16 v[64:79], v[160:163], v[168:171], v[64:79]
    ds_read_b64_tr_b16 v[144:145], v12 offset:36864
    ds_read_b64_tr_b16 v[146:147], v12 offset:37888
    v_mfma_f32_32x32x16_bf16 v[80:95], v[160:163], v[172:175], v[80:95]
    ds_read_b64_tr_b16 v[148:149], v13 offset:36864
    ds_read_b64_tr_b16 v[150:151], v13 offset:37888
    v_mfma_f32_32x32x16_bf16 v[96:111], v[164:167], v[168:171], v[96:111]
    ds_read_b128 v[152:155], v19 offset:32768
    ds_read_b128 v[156:159], v19 offset:36864
    v_mfma_f32_32x32x16_bf16 v[112:127], v[164:167], v[172:175], v[112:127]
    s_waitcnt lgkmcnt(6)
    v_mfma_f32_32x32x16_bf16 v[64:79], v[128:131], v[136:139], v[64:79]
    ds_read_b64_tr_b16 v[160:161], v12 offset:40960
    ds_read_b64_tr_b16 v[162:163], v12 offset:41984
    v_mfma_f32_32x32x16_bf16 v[80:95], v[128:131], v[140:143], v[80:95]
    ds_read_b64_tr_b16 v[164:165], v13 offset:40960
    ds_read_b64_tr_b16 v[166:167], v13 offset:41984
    v_mfma_f32_32x32x16_bf16 v[96:111], v[132:135], v[136:139], v[96:111]
    ds_read_b128 v[168:171], v20 offset:32768
    ds_read_b128 v[172:175], v20 offset:36864
    v_mfma_f32_32x32x16_bf16 v[112:127], v[132:135], v[140:143], v[112:127]
    s_waitcnt lgkmcnt(6)
    v_mfma_f32_32x32x16_bf16 v[64:79], v[144:147], v[152:155], v[64:79]
    ds_read_b64_tr_b16 v[128:129], v12 offset:45056
    ds_read_b64_tr_b16 v[130:131], v12 offset:46080
    v_mfma_f32_32x32x16_bf16 v[80:95], v[144:147], v[156:159], v[80:95]
    ds_read_b64_tr_b16 v[132:133], v13 offset:45056
    ds_read_b64_tr_b16 v[134:135], v13 offset:46080
    v_mfma_f32_32x32x16_bf16 v[96:111], v[148:151], v[152:155], v[96:111]
    ds_read_b128 v[136:139], v21 offset:32768
    ds_read_b128 v[140:143], v21 offset:36864
    v_mfma_f32_32x32x16_bf16 v[112:127], v[148:151], v[156:159], v[112:127]
    s_waitcnt lgkmcnt(0)
    s_barrier
    ds_read_b64_tr_b16 v[208:209], v28 offset:0
    ds_read_b64_tr_b16 v[210:211], v28 offset:2560
    ds_read_b64_tr_b16 v[212:213], v28 offset:32
    ds_read_b64_tr_b16 v[214:215], v28 offset:2592
    s_lshl_b32 s24, s34, 5
    v_subrev_u32 v30, s24, v28
    ds_read_b64_tr_b16 v[216:217], v30 offset:64
    ds_read_b64_tr_b16 v[218:219], v30 offset:2624
    v_mfma_f32_32x32x16_bf16 v[64:79], v[160:163], v[168:171], v[64:79]
    ds_read_b64_tr_b16 v[144:145], v10 offset:0
    ds_read_b64_tr_b16 v[146:147], v10 offset:1024
    v_mfma_f32_32x32x16_bf16 v[80:95], v[160:163], v[172:175], v[80:95]
    ds_read_b64_tr_b16 v[148:149], v11 offset:0
    ds_read_b64_tr_b16 v[150:151], v11 offset:1024
    v_mfma_f32_32x32x16_bf16 v[96:111], v[164:167], v[168:171], v[96:111]
    ds_read_b128 v[152:155], v14 offset:0
    ds_read_b128 v[156:159], v14 offset:4096
    v_mfma_f32_32x32x16_bf16 v[112:127], v[164:167], v[172:175], v[112:127]
    s_waitcnt lgkmcnt(6)
    v_mfma_f32_32x32x16_bf16 v[64:79], v[128:131], v[136:139], v[64:79]
    ds_read_b64_tr_b16 v[160:161], v10 offset:4096
    ds_read_b64_tr_b16 v[162:163], v10 offset:5120
    v_mfma_f32_32x32x16_bf16 v[80:95], v[128:131], v[140:143], v[80:95]
    ds_read_b64_tr_b16 v[164:165], v11 offset:4096
    ds_read_b64_tr_b16 v[166:167], v11 offset:5120
    v_mfma_f32_32x32x16_bf16 v[96:111], v[132:135], v[136:139], v[96:111]
    ds_read_b128 v[168:171], v15 offset:0
    ds_read_b128 v[172:175], v15 offset:4096
    v_mfma_f32_32x32x16_bf16 v[112:127], v[132:135], v[140:143], v[112:127]
    s_waitcnt lgkmcnt(6)
    v_mfma_f32_32x32x16_bf16 v[64:79], v[144:147], v[152:155], v[64:79]
    ds_read_b64_tr_b16 v[128:129], v10 offset:8192
    ds_read_b64_tr_b16 v[130:131], v10 offset:9216
    v_mfma_f32_32x32x16_bf16 v[80:95], v[144:147], v[156:159], v[80:95]
    ds_read_b64_tr_b16 v[132:133], v11 offset:8192
    ds_read_b64_tr_b16 v[134:135], v11 offset:9216
    v_mfma_f32_32x32x16_bf16 v[96:111], v[148:151], v[152:155], v[96:111]
    ds_read_b128 v[136:139], v16 offset:0
    ds_read_b128 v[140:143], v16 offset:4096
    v_mfma_f32_32x32x16_bf16 v[112:127], v[148:151], v[156:159], v[112:127]
    s_waitcnt lgkmcnt(6)
    v_mfma_f32_32x32x16_bf16 v[64:79], v[160:163], v[168:171], v[64:79]
    ds_read_b64_tr_b16 v[144:145], v10 offset:12288
    ds_read_b64_tr_b16 v[146:147], v10 offset:13312
    v_mfma_f32_32x32x16_bf16 v[80:95], v[160:163], v[172:175], v[80:95]
    ds_read_b64_tr_b16 v[148:149], v11 offset:12288
    ds_read_b64_tr_b16 v[150:151], v11 offset:13312
    v_mfma_f32_32x32x16_bf16 v[96:111], v[164:167], v[168:171], v[96:111]
    ds_read_b128 v[152:155], v17 offset:0
    ds_read_b128 v[156:159], v17 offset:4096
    v_mfma_f32_32x32x16_bf16 v[112:127], v[164:167], v[172:175], v[112:127]
    s_waitcnt lgkmcnt(0)
    s_barrier
    buffer_store_dwordx4 v[208:211], v29, s[8:11], s38 offen sc1
    buffer_store_dwordx4 v[212:215], v29, s[8:11], s38 offen offset:1024 sc1
    buffer_store_dwordx4 v[216:219], v29, s[8:11], s39 offen sc1
    v_mfma_f32_32x32x16_bf16 v[64:79], v[128:131], v[136:139], v[64:79]
    ds_read_b64_tr_b16 v[160:161], v10 offset:32768
    ds_read_b64_tr_b16 v[162:163], v10 offset:33792
    v_mfma_f32_32x32x16_bf16 v[80:95], v[128:131], v[140:143], v[80:95]
    ds_read_b64_tr_b16 v[164:165], v11 offset:32768
    ds_read_b64_tr_b16 v[166:167], v11 offset:33792
    v_mfma_f32_32x32x16_bf16 v[96:111], v[132:135], v[136:139], v[96:111]
    ds_read_b128 v[168:171], v14 offset:32768
    ds_read_b128 v[172:175], v14 offset:36864
    v_mfma_f32_32x32x16_bf16 v[112:127], v[132:135], v[140:143], v[112:127]
    s_waitcnt lgkmcnt(6)
    v_mfma_f32_32x32x16_bf16 v[64:79], v[144:147], v[152:155], v[64:79]
    ds_read_b64_tr_b16 v[128:129], v10 offset:36864
    ds_read_b64_tr_b16 v[130:131], v10 offset:37888
    v_mfma_f32_32x32x16_bf16 v[80:95], v[144:147], v[156:159], v[80:95]
    ds_read_b64_tr_b16 v[132:133], v11 offset:36864
    ds_read_b64_tr_b16 v[134:135], v11 offset:37888
    v_mfma_f32_32x32x16_bf16 v[96:111], v[148:151], v[152:155], v[96:111]
    ds_read_b128 v[136:139], v15 offset:32768
    ds_read_b128 v[140:143], v15 offset:36864
    v_mfma_f32_32x32x16_bf16 v[112:127], v[148:151], v[156:159], v[112:127]
    s_waitcnt lgkmcnt(6)
    v_mfma_f32_32x32x16_bf16 v[64:79], v[160:163], v[168:171], v[64:79]
    ds_read_b64_tr_b16 v[144:145], v10 offset:40960
    ds_read_b64_tr_b16 v[146:147], v10 offset:41984
    v_mfma_f32_32x32x16_bf16 v[80:95], v[160:163], v[172:175], v[80:95]
    ds_read_b64_tr_b16 v[148:149], v11 offset:40960
    ds_read_b64_tr_b16 v[150:151], v11 offset:41984
    v_mfma_f32_32x32x16_bf16 v[96:111], v[164:167], v[168:171], v[96:111]
    ds_read_b128 v[152:155], v16 offset:32768
    ds_read_b128 v[156:159], v16 offset:36864
    v_mfma_f32_32x32x16_bf16 v[112:127], v[164:167], v[172:175], v[112:127]
    s_waitcnt lgkmcnt(6)
    v_mfma_f32_32x32x16_bf16 v[64:79], v[128:131], v[136:139], v[64:79]
    ds_read_b64_tr_b16 v[160:161], v10 offset:45056
    ds_read_b64_tr_b16 v[162:163], v10 offset:46080
    v_mfma_f32_32x32x16_bf16 v[80:95], v[128:131], v[140:143], v[80:95]
    ds_read_b64_tr_b16 v[164:165], v11 offset:45056
    ds_read_b64_tr_b16 v[166:167], v11 offset:46080
    v_mfma_f32_32x32x16_bf16 v[96:111], v[132:135], v[136:139], v[96:111]
    ds_read_b128 v[168:171], v17 offset:32768
    ds_read_b128 v[172:175], v17 offset:36864
    v_mfma_f32_32x32x16_bf16 v[112:127], v[132:135], v[140:143], v[112:127]
    s_waitcnt lgkmcnt(0)
    s_barrier
    v_mfma_f32_32x32x16_bf16 v[64:79], v[144:147], v[152:155], v[64:79]
    ds_read_b64_tr_b16 v[128:129], v12 offset:0
    ds_read_b64_tr_b16 v[130:131], v12 offset:1024
    v_mfma_f32_32x32x16_bf16 v[80:95], v[144:147], v[156:159], v[80:95]
    ds_read_b64_tr_b16 v[132:133], v13 offset:0
    ds_read_b64_tr_b16 v[134:135], v13 offset:1024
    v_mfma_f32_32x32x16_bf16 v[96:111], v[148:151], v[152:155], v[96:111]
    ds_read_b128 v[136:139], v18 offset:0
    ds_read_b128 v[140:143], v18 offset:4096
    v_mfma_f32_32x32x16_bf16 v[112:127], v[148:151], v[156:159], v[112:127]
    s_waitcnt lgkmcnt(6)
    v_mfma_f32_32x32x16_bf16 v[64:79], v[160:163], v[168:171], v[64:79]
    ds_read_b64_tr_b16 v[144:145], v12 offset:4096
    ds_read_b64_tr_b16 v[146:147], v12 offset:5120
    v_mfma_f32_32x32x16_bf16 v[80:95], v[160:163], v[172:175], v[80:95]
    ds_read_b64_tr_b16 v[148:149], v13 offset:4096
    ds_read_b64_tr_b16 v[150:151], v13 offset:5120
    v_mfma_f32_32x32x16_bf16 v[96:111], v[164:167], v[168:171], v[96:111]
    ds_read_b128 v[152:155], v19 offset:0
    ds_read_b128 v[156:159], v19 offset:4096
    v_mfma_f32_32x32x16_bf16 v[112:127], v[164:167], v[172:175], v[112:127]
    s_waitcnt lgkmcnt(6)
    v_mfma_f32_32x32x16_bf16 v[64:79], v[128:131], v[136:139], v[64:79]
    ds_read_b64_tr_b16 v[160:161], v12 offset:8192
    ds_read_b64_tr_b16 v[162:163], v12 offset:9216
    v_mfma_f32_32x32x16_bf16 v[80:95], v[128:131], v[140:143], v[80:95]
    ds_read_b64_tr_b16 v[164:165], v13 offset:8192
    ds_read_b64_tr_b16 v[166:167], v13 offset:9216
    v_mfma_f32_32x32x16_bf16 v[96:111], v[132:135], v[136:139], v[96:111]
    ds_read_b128 v[168:171], v20 offset:0
    ds_read_b128 v[172:175], v20 offset:4096
    v_mfma_f32_32x32x16_bf16 v[112:127], v[132:135], v[140:143], v[112:127]
    s_waitcnt lgkmcnt(6)
    v_mfma_f32_32x32x16_bf16 v[64:79], v[144:147], v[152:155], v[64:79]
    ds_read_b64_tr_b16 v[128:129], v12 offset:12288
    ds_read_b64_tr_b16 v[130:131], v12 offset:13312
    v_mfma_f32_32x32x16_bf16 v[80:95], v[144:147], v[156:159], v[80:95]
    ds_read_b64_tr_b16 v[132:133], v13 offset:12288
    ds_read_b64_tr_b16 v[134:135], v13 offset:13312
    v_mfma_f32_32x32x16_bf16 v[96:111], v[148:151], v[152:155], v[96:111]
    ds_read_b128 v[136:139], v21 offset:0
    ds_read_b128 v[140:143], v21 offset:4096
    v_mfma_f32_32x32x16_bf16 v[112:127], v[148:151], v[156:159], v[112:127]
    s_waitcnt lgkmcnt(0)
    s_barrier
    v_mfma_f32_32x32x16_bf16 v[64:79], v[160:163], v[168:171], v[64:79]
    ds_read_b64_tr_b16 v[144:145], v12 offset:32768
    ds_read_b64_tr_b16 v[146:147], v12 offset:33792
    v_mfma_f32_32x32x16_bf16 v[80:95], v[160:163], v[172:175], v[80:95]
    ds_read_b64_tr_b16 v[148:149], v13 offset:32768
    ds_read_b64_tr_b16 v[150:151], v13 offset:33792
    v_mfma_f32_32x32x16_bf16 v[96:111], v[164:167], v[168:171], v[96:111]
    ds_read_b128 v[152:155], v18 offset:32768
    ds_read_b128 v[156:159], v18 offset:36864
    v_mfma_f32_32x32x16_bf16 v[112:127], v[164:167], v[172:175], v[112:127]
    s_waitcnt lgkmcnt(6)
    v_mfma_f32_32x32x16_bf16 v[64:79], v[128:131], v[136:139], v[64:79]
    ds_read_b64_tr_b16 v[160:161], v12 offset:36864
    ds_read_b64_tr_b16 v[162:163], v12 offset:37888
    v_mfma_f32_32x32x16_bf16 v[80:95], v[128:131], v[140:143], v[80:95]
    ds_read_b64_tr_b16 v[164:165], v13 offset:36864
    ds_read_b64_tr_b16 v[166:167], v13 offset:37888
    v_mfma_f32_32x32x16_bf16 v[96:111], v[132:135], v[136:139], v[96:111]
    ds_read_b128 v[168:171], v19 offset:32768
    ds_read_b128 v[172:175], v19 offset:36864
    v_mfma_f32_32x32x16_bf16 v[112:127], v[132:135], v[140:143], v[112:127]
    s_waitcnt lgkmcnt(6)
    v_mfma_f32_32x32x16_bf16 v[64:79], v[144:147], v[152:155], v[64:79]
    ds_read_b64_tr_b16 v[128:129], v12 offset:40960
    ds_read_b64_tr_b16 v[130:131], v12 offset:41984
    v_mfma_f32_32x32x16_bf16 v[80:95], v[144:147], v[156:159], v[80:95]
    ds_read_b64_tr_b16 v[132:133], v13 offset:40960
    ds_read_b64_tr_b16 v[134:135], v13 offset:41984
    v_mfma_f32_32x32x16_bf16 v[96:111], v[148:151], v[152:155], v[96:111]
    ds_read_b128 v[136:139], v20 offset:32768
    ds_read_b128 v[140:143], v20 offset:36864
    v_mfma_f32_32x32x16_bf16 v[112:127], v[148:151], v[156:159], v[112:127]
    s_waitcnt lgkmcnt(6)
    v_mfma_f32_32x32x16_bf16 v[64:79], v[160:163], v[168:171], v[64:79]
    ds_read_b64_tr_b16 v[144:145], v12 offset:45056
    ds_read_b64_tr_b16 v[146:147], v12 offset:46080
    v_mfma_f32_32x32x16_bf16 v[80:95], v[160:163], v[172:175], v[80:95]
    ds_read_b64_tr_b16 v[148:149], v13 offset:45056
    ds_read_b64_tr_b16 v[150:151], v13 offset:46080
    v_mfma_f32_32x32x16_bf16 v[96:111], v[164:167], v[168:171], v[96:111]
    ds_read_b128 v[152:155], v21 offset:32768
    ds_read_b128 v[156:159], v21 offset:36864
    v_mfma_f32_32x32x16_bf16 v[112:127], v[164:167], v[172:175], v[112:127]
    s_waitcnt lgkmcnt(0)
    s_barrier
    v_mfma_f32_32x32x16_bf16 v[64:79], v[128:131], v[136:139], v[64:79]
    ds_read_b64_tr_b16 v[160:161], v10 offset:0
    ds_read_b64_tr_b16 v[162:163], v10 offset:1024
    v_mfma_f32_32x32x16_bf16 v[80:95], v[128:131], v[140:143], v[80:95]
    ds_read_b64_tr_b16 v[164:165], v11 offset:0
    ds_read_b64_tr_b16 v[166:167], v11 offset:1024
    v_mfma_f32_32x32x16_bf16 v[96:111], v[132:135], v[136:139], v[96:111]
    ds_read_b128 v[168:171], v14 offset:0
    ds_read_b128 v[172:175], v14 offset:4096
    v_mfma_f32_32x32x16_bf16 v[112:127], v[132:135], v[140:143], v[112:127]
    s_waitcnt lgkmcnt(6)
    v_mfma_f32_32x32x16_bf16 v[64:79], v[144:147], v[152:155], v[64:79]
    ds_read_b64_tr_b16 v[128:129], v10 offset:4096
    ds_read_b64_tr_b16 v[130:131], v10 offset:5120
    v_mfma_f32_32x32x16_bf16 v[80:95], v[144:147], v[156:159], v[80:95]
    ds_read_b64_tr_b16 v[132:133], v11 offset:4096
    ds_read_b64_tr_b16 v[134:135], v11 offset:5120
    v_mfma_f32_32x32x16_bf16 v[96:111], v[148:151], v[152:155], v[96:111]
    ds_read_b128 v[136:139], v15 offset:0
    ds_read_b128 v[140:143], v15 offset:4096
    v_mfma_f32_32x32x16_bf16 v[112:127], v[148:151], v[156:159], v[112:127]
    s_waitcnt lgkmcnt(6)
    v_mfma_f32_32x32x16_bf16 v[64:79], v[160:163], v[168:171], v[64:79]
    ds_read_b64_tr_b16 v[144:145], v10 offset:8192
    ds_read_b64_tr_b16 v[146:147], v10 offset:9216
    v_mfma_f32_32x32x16_bf16 v[80:95], v[160:163], v[172:175], v[80:95]
    ds_read_b64_tr_b16 v[148:149], v11 offset:8192
    ds_read_b64_tr_b16 v[150:151], v11 offset:9216
    v_mfma_f32_32x32x16_bf16 v[96:111], v[164:167], v[168:171], v[96:111]
    ds_read_b128 v[152:155], v16 offset:0
    ds_read_b128 v[156:159], v16 offset:4096
    v_mfma_f32_32x32x16_bf16 v[112:127], v[164:167], v[172:175], v[112:127]
    s_waitcnt lgkmcnt(6)
    v_mfma_f32_32x32x16_bf16 v[64:79], v[128:131], v[136:139], v[64:79]
    ds_read_b64_tr_b16 v[160:161], v10 offset:12288
    ds_read_b64_tr_b16 v[162:163], v10 offset:13312
    v_mfma_f32_32x32x16_bf16 v[80:95], v[128:131], v[140:143], v[80:95]
    ds_read_b64_tr_b16 v[164:165], v11 offset:12288
    ds_read_b64_tr_b16 v[166:167], v11 offset:13312
    v_mfma_f32_32x32x16_bf16 v[96:111], v[132:135], v[136:139], v[96:111]
    ds_read_b128 v[168:171], v17 offset:0
    ds_read_b128 v[172:175], v17 offset:4096
    v_mfma_f32_32x32x16_bf16 v[112:127], v[132:135], v[140:143], v[112:127]
    s_waitcnt lgkmcnt(0)
    s_barrier
    s_waitcnt vmcnt(0)
    v_mov_b32 v222, 156764
    v_mov_b32 v223, 1
    s_mov_b64 exec, 1
    ds_add_rtn_u32 v223, v222, v223
    s_mov_b64 exec, -1
    s_waitcnt lgkmcnt(0)
    v_readfirstlane_b32 s24, v223
    s_nop 3
    s_cmp_lg_u32 s24, 3
    s_cbranch_scc1 nwd_2
    v_mov_b32 v222, s28
    buffer_store_dword v222, v221, s[40:43], 0 offen sc1
nwd_2:
    v_mfma_f32_32x32x16_bf16 v[64:79], v[144:147], v[152:155], v[64:79]
    ds_read_b64_tr_b16 v[128:129], v10 offset:32768
    ds_read_b64_tr_b16 v[130:131], v10 offset:33792
    v_mfma_f32_32x32x16_bf16 v[80:95], v[144:147], v[156:159], v[80:95]
    ds_read_b64_tr_b16 v[132:133], v11 offset:32768
    ds_read_b64_tr_b16 v[134:135], v11 offset:33792
    v_mfma_f32_32x32x16_bf16 v[96:111], v[148:151], v[152:155], v[96:111]
    ds_read_b128 v[136:139], v14 offset:32768
    ds_read_b128 v[140:143], v14 offset:36864
    v_mfma_f32_32x32x16_bf16 v[112:127], v[148:151], v[156:159], v[112:127]
    s_waitcnt lgkmcnt(6)
    v_mfma_f32_32x32x16_bf16 v[64:79], v[160:163], v[168:171], v[64:79]
    ds_read_b64_tr_b16 v[144:145], v10 offset:36864
    ds_read_b64_tr_b16 v[146:147], v10 offset:37888
    v_mfma_f32_32x32x16_bf16 v[80:95], v[160:163], v[172:175], v[80:95]
    ds_read_b64_tr_b16 v[148:149], v11 offset:36864
    ds_read_b64_tr_b16 v[150:151], v11 offset:37888
    v_mfma_f32_32x32x16_bf16 v[96:111], v[164:167], v[168:171], v[96:111]
    ds_read_b128 v[152:155], v15 offset:32768
    ds_read_b128 v[156:159], v15 offset:36864
    v_mfma_f32_32x32x16_bf16 v[112:127], v[164:167], v[172:175], v[112:127]
    s_waitcnt lgkmcnt(6)
    v_mfma_f32_32x32x16_bf16 v[64:79], v[128:131], v[136:139], v[64:79]
    ds_read_b64_tr_b16 v[160:161], v10 offset:40960
    ds_read_b64_tr_b16 v[162:163], v10 offset:41984
    v_mfma_f32_32x32x16_bf16 v[80:95], v[128:131], v[140:143], v[80:95]
    ds_read_b64_tr_b16 v[164:165], v11 offset:40960
    ds_read_b64_tr_b16 v[166:167], v11 offset:41984
    v_mfma_f32_32x32x16_bf16 v[96:111], v[132:135], v[136:139], v[96:111]
    ds_read_b128 v[168:171], v16 offset:32768
    ds_read_b128 v[172:175], v16 offset:36864
    v_mfma_f32_32x32x16_bf16 v[112:127], v[132:135], v[140:143], v[112:127]
    s_waitcnt lgkmcnt(6)
    v_mfma_f32_32x32x16_bf16 v[64:79], v[144:147], v[152:155], v[64:79]
    ds_read_b64_tr_b16 v[128:129], v10 offset:45056
    ds_read_b64_tr_b16 v[130:131], v10 offset:46080
    v_mfma_f32_32x32x16_bf16 v[80:95], v[144:147], v[156:159], v[80:95]
    ds_read_b64_tr_b16 v[132:133], v11 offset:45056
    ds_read_b64_tr_b16 v[134:135], v11 offset:46080
    v_mfma_f32_32x32x16_bf16 v[96:111], v[148:151], v[152:155], v[96:111]
    ds_read_b128 v[136:139], v17 offset:32768
    ds_read_b128 v[140:143], v17 offset:36864
    v_mfma_f32_32x32x16_bf16 v[112:127], v[148:151], v[156:159], v[112:127]
    s_waitcnt lgkmcnt(6)
    v_mfma_f32_32x32x16_bf16 v[64:79], v[160:163], v[168:171], v[64:79]
    v_mfma_f32_32x32x16_bf16 v[80:95], v[160:163], v[172:175], v[80:95]
    v_mfma_f32_32x32x16_bf16 v[96:111], v[164:167], v[168:171], v[96:111]
    v_mfma_f32_32x32x16_bf16 v[112:127], v[164:167], v[172:175], v[112:127]
    s_waitcnt lgkmcnt(0)
    v_mfma_f32_32x32x16_bf16 v[64:79], v[128:131], v[136:139], v[64:79]
    v_mfma_f32_32x32x16_bf16 v[80:95], v[128:131], v[140:143], v[80:95]
    v_mfma_f32_32x32x16_bf16 v[96:111], v[132:135], v[136:139], v[96:111]
    v_mfma_f32_32x32x16_bf16 v[112:127], v[132:135], v[140:143], v[112:127]
    s_barrier
    ds_read_b128 v[144:147], v24 offset:0
    ds_read_b128 v[148:151], v24 offset:1024
    ds_read_b128 v[152:155], v25 offset:4096
    ds_read_b128 v[156:159], v25 offset:5120
    s_waitcnt lgkmcnt(0)
    v_mfma_f32_32x32x16_bf16 v[64:79], v[144:147], v[152:155], v[64:79]
    v_mfma_f32_32x32x16_bf16 v[80:95], v[144:147], v[156:159], v[80:95]
    v_mfma_f32_32x32x16_bf16 v[96:111], v[148:151], v[152:155], v[96:111]
    v_mfma_f32_32x32x16_bf16 v[112:127], v[148:151], v[156:159], v[112:127]
    s_nop 15
    v_mul_f32 v64, v64, abs(v64)
    v_mul_f32 v65, v65, abs(v65)
    v_cvt_pk_bf16_f32 v176, v64, v65
    v_pk_max_i16 v176, v176, 0
    v_mul_f32 v66, v66, abs(v66)
    v_mul_f32 v67, v67, abs(v67)
    v_cvt_pk_bf16_f32 v177, v66, v67
    v_pk_max_i16 v177, v177, 0
    v_mul_f32 v68, v68, abs(v68)
    v_mul_f32 v69, v69, abs(v69)
    v_cvt_pk_bf16_f32 v178, v68, v69
    v_pk_max_i16 v178, v178, 0
    v_mul_f32 v70, v70, abs(v70)
    v_mul_f32 v71, v71, abs(v71)
    v_cvt_pk_bf16_f32 v179, v70, v71
    v_pk_max_i16 v179, v179, 0
    v_mul_f32 v72, v72, abs(v72)
    v_mul_f32 v73, v73, abs(v73)
    v_cvt_pk_bf16_f32 v180, v72, v73
    v_pk_max_i16 v180, v180, 0
    v_mul_f32 v74, v74, abs(v74)
    v_mul_f32 v75, v75, abs(v75)
    v_cvt_pk_bf16_f32 v181, v74, v75
    v_pk_max_i16 v181, v181, 0
    v_mul_f32 v76, v76, abs(v76)
    v_mul_f32 v77, v77, abs(v77)
    v_cvt_pk_bf16_f32 v182, v76, v77
    v_pk_max_i16 v182, v182, 0
    v_mul_f32 v78, v78, abs(v78)
    v_mul_f32 v79, v79, abs(v79)
    v_cvt_pk_bf16_f32 v183, v78, v79
    v_pk_max_i16 v183, v183, 0
    buffer_store_dwordx4 v[176:179], v22, s[16:19], s36 offen offset:0 sc1
    buffer_store_dwordx4 v[180:183], v22, s[16:19], s36 offen offset:512 sc1
    v_mul_f32 v80, v80, abs(v80)
    v_mul_f32 v81, v81, abs(v81)
    v_cvt_pk_bf16_f32 v184, v80, v81
    v_pk_max_i16 v184, v184, 0
    v_mul_f32 v82, v82, abs(v82)
    v_mul_f32 v83, v83, abs(v83)
    v_cvt_pk_bf16_f32 v185, v82, v83
    v_pk_max_i16 v185, v185, 0
    v_mul_f32 v84, v84, abs(v84)
    v_mul_f32 v85, v85, abs(v85)
    v_cvt_pk_bf16_f32 v186, v84, v85
    v_pk_max_i16 v186, v186, 0
    v_mul_f32 v86, v86, abs(v86)
    v_mul_f32 v87, v87, abs(v87)
    v_cvt_pk_bf16_f32 v187, v86, v87
    v_pk_max_i16 v187, v187, 0
    v_mul_f32 v88, v88, abs(v88)
    v_mul_f32 v89, v89, abs(v89)
    v_cvt_pk_bf16_f32 v188, v88, v89
    v_pk_max_i16 v188, v188, 0
    v_mul_f32 v90, v90, abs(v90)
    v_mul_f32 v91, v91, abs(v91)
    v_cvt_pk_bf16_f32 v189, v90, v91
    v_pk_max_i16 v189, v189, 0
    v_mul_f32 v92, v92, abs(v92)
    v_mul_f32 v93, v93, abs(v93)
    v_cvt_pk_bf16_f32 v190, v92, v93
    v_pk_max_i16 v190, v190, 0
    v_mul_f32 v94, v94, abs(v94)
    v_mul_f32 v95, v95, abs(v95)
    v_cvt_pk_bf16_f32 v191, v94, v95
    v_pk_max_i16 v191, v191, 0
    buffer_store_dwordx4 v[184:187], v22, s[16:19], s36 offen offset:2048 sc1
    buffer_store_dwordx4 v[188:191], v22, s[16:19], s36 offen offset:2560 sc1
    v_mul_f32 v96, v96, abs(v96)
    v_mul_f32 v97, v97, abs(v97)
    v_cvt_pk_bf16_f32 v192, v96, v97
    v_pk_max_i16 v192, v192, 0
    v_mul_f32 v98, v98, abs(v98)
    v_mul_f32 v99, v99, abs(v99)
    v_cvt_pk_bf16_f32 v193, v98, v99
    v_pk_max_i16 v193, v193, 0
    v_mul_f32 v100, v100, abs(v100)
    v_mul_f32 v101, v101, abs(v101)
    v_cvt_pk_bf16_f32 v194, v100, v101
    v_pk_max_i16 v194, v194, 0
    v_mul_f32 v102, v102, abs(v102)
    v_mul_f32 v103, v103, abs(v103)
    v_cvt_pk_bf16_f32 v195, v102, v103
    v_pk_max_i16 v195, v195, 0
    v_mul_f32 v104, v104, abs(v104)
    v_mul_f32 v105, v105, abs(v105)
    v_cvt_pk_bf16_f32 v196, v104, v105
    v_pk_max_i16 v196, v196, 0
    v_mul_f32 v106, v106, abs(v106)
    v_mul_f32 v107, v107, abs(v107)
    v_cvt_pk_bf16_f32 v197, v106, v107
    v_pk_max_i16 v197, v197, 0
    v_mul_f32 v108, v108, abs(v108)
    v_mul_f32 v109, v109, abs(v109)
    v_cvt_pk_bf16_f32 v198, v108, v109
    v_pk_max_i16 v198, v198, 0
    v_mul_f32 v110, v110, abs(v110)
    v_mul_f32 v111, v111, abs(v111)
    v_cvt_pk_bf16_f32 v199, v110, v111
    v_pk_max_i16 v199, v199, 0
    buffer_store_dwordx4 v[192:195], v22, s[16:19], s37 offen offset:0 sc1
    buffer_store_dwordx4 v[196:199], v22, s[16:19], s37 offen offset:512 sc1
    v_mul_f32 v112, v112, abs(v112)
    v_mul_f32 v113, v113, abs(v113)
    v_cvt_pk_bf16_f32 v200, v112, v113
    v_pk_max_i16 v200, v200, 0
    v_mul_f32 v114, v114, abs(v114)
    v_mul_f32 v115, v115, abs(v115)
    v_cvt_pk_bf16_f32 v201, v114, v115
    v_pk_max_i16 v201, v201, 0
    v_mul_f32 v116, v116, abs(v116)
    v_mul_f32 v117, v117, abs(v117)
    v_cvt_pk_bf16_f32 v202, v116, v117
    v_pk_max_i16 v202, v202, 0
    v_mul_f32 v118, v118, abs(v118)
    v_mul_f32 v119, v119, abs(v119)
    v_cvt_pk_bf16_f32 v203, v118, v119
    v_pk_max_i16 v203, v203, 0
    v_mul_f32 v120, v120, abs(v120)
    v_mul_f32 v121, v121, abs(v121)
    v_cvt_pk_bf16_f32 v204, v120, v121
    v_pk_max_i16 v204, v204, 0
    v_mul_f32 v122, v122, abs(v122)
    v_mul_f32 v123, v123, abs(v123)
    v_cvt_pk_bf16_f32 v205, v122, v123
    v_pk_max_i16 v205, v205, 0
    v_mul_f32 v124, v124, abs(v124)
    v_mul_f32 v125, v125, abs(v125)
    v_cvt_pk_bf16_f32 v206, v124, v125
    v_pk_max_i16 v206, v206, 0
    v_mul_f32 v126, v126, abs(v126)
    v_mul_f32 v127, v127, abs(v127)
    v_cvt_pk_bf16_f32 v207, v126, v127
    v_pk_max_i16 v207, v207, 0
    buffer_store_dwordx4 v[200:203], v22, s[16:19], s37 offen offset:2048 sc1
    buffer_store_dwordx4 v[204:207], v22, s[16:19], s37 offen offset:2560 sc1
    v_lshrrev_b32 v210, 3, v2
    s_lshl_b32 s24, s22, 1
    v_add_u32 v210, s24, v210
    v_and_b32 v211, 7, v2
    v_lshrrev_b32 v212, 3, v210
    v_lshlrev_b32 v212, 1, v212
    v_lshrrev_b32 v213, 2, v211
    v_add_u32 v212, v212, v213
    v_and_b32 v213, 3, v211
    v_lshlrev_b32 v213, 6, v213
    v_add_u32 v212, v212, v213
    v_and_b32 v213, 7, v210
    v_lshl_add_u32 v212, v213, 3, v212
    v_lshlrev_b32 v212, 9, v212
    s_lshl_b32 s24, s23, 2
    s_add_u32 s24, s24, 194560
    v_add_u32 v212, s24, v212
    s_lshl_b32 s38, s2, 7
    s_add_u32 s38, s38, 169984
    s_and_b32 s24, s2, 7
    s_lshr_b32 s25, s2, 3
    s_lshr_b32 s26, s24, 1
    s_lshl_b32 s26, s26, 3
    s_and_b32 s30, s25, 7
    s_add_u32 s30, s26, s30
    s_and_b32 s26, s24, 1
    s_lshl_b32 s26, s26, 2
    s_lshr_b32 s31, s25, 3
    s_add_u32 s31, s26, s31
    v_and_b32 v2, 63, v0
    v_lshlrev_b32 v3, 4, v2
    v_add_u32 v4, 4096, v3
    s_mul_i32 s24, s29, 12
    s_mul_i32 s25, s30, 48
    s_add_u32 s25, s25, s24
    s_lshl_b32 s32, s25, 12
    s_mul_i32 s25, s31, 48
    s_add_u32 s25, s25, s24
    s_mul_i32 s33, s25, 5120
    s_mov_b64 s[4:5], s[98:99]
    s_and_b32 s5, s5, 0xffff
    s_mov_b32 s6, 6291456
    s_mov_b32 s7, 0x00020000
    s_mov_b64 s[8:9], s[98:99]
    s_add_u32 s8, s8, 6291456
    s_addc_u32 s9, s9, 0
    s_and_b32 s9, s9, 0xffff
    s_mov_b32 s10, 1966080
    s_mov_b32 s11, 0x00020000
    s_mov_b64 s[12:13], s[72:73]
    s_and_b32 s13, s13, 0xffff
    s_mov_b32 s14, 2621440
    s_mov_b32 s15, 0x00020000
    s_mov_b64 s[16:17], s[98:99]
    s_add_u32 s16, s16, 10878976
    s_addc_u32 s17, s17, 0
    s_and_b32 s17, s17, 0xffff
    s_mov_b32 s18, 2621440
    s_mov_b32 s19, 0x00020000
    s_mov_b64 s[52:53], s[98:99]
    s_add_u32 s52, s52, 13500416
    s_addc_u32 s53, s53, 0
    s_and_b32 s53, s53, 0xffff
    s_mov_b32 s54, 16384
    s_mov_b32 s55, 0x00020000
    s_mov_b64 s[20:21], s[92:93]
    s_and_b32 s21, s21, 0xffff
    s_mov_b32 s22, 1280
    s_mov_b32 s23, 0x00020000
    v_and_b32 v5, 15, v2
    v_lshrrev_b32 v8, 4, v2
    s_lshl_b32 s24, s30, 6
    s_lshl_b32 s25, s29, 4
    s_add_u32 s24, s24, s25
    v_add_u32 v5, s24, v5
    v_lshlrev_b32 v9, 3, v5
    s_movk_i32 s26, 1280
    v_mul_lo_u32 v20, v5, s26
    s_mul_i32 s27, s31, 160
    v_lshlrev_b32 v21, 3, v8
    v_add_u32 v21, s27, v21
    v_add_u32 v20, v20, v21
    v_lshlrev_b32 v22, 7, v2
    s_waitcnt vmcnt(0)
    v_mov_b32 v214, 156740
    v_mov_b32 v215, 1
    s_mov_b64 exec, 1
    ds_add_rtn_u32 v215, v214, v215
    s_mov_b64 exec, -1
    s_waitcnt lgkmcnt(0)
    v_readfirstlane_b32 s24, v215
    s_nop 3
    s_cmp_lg_u32 s24, 3
    s_cbranch_scc1 nh_3
    v_mov_b32 v214, s28
    s_mov_b64 s[48:49], exec
    s_mov_b64 exec, 0xffff
    buffer_store_dword v214, v212, s[40:43], 0 offen sc1
    s_mov_b64 exec, s[48:49]
    v_mov_b32 v214, s28
    v_mov_b32 v215, 0
    s_mov_b64 s[48:49], exec
    s_mov_b64 exec, 1
    buffer_store_dword v214, v215, s[40:43], s38 offen offset:0 sc1
    s_mov_b64 exec, s[48:49]
nh_3:
    s_cmp_lg_u32 s29, 0
    s_cbranch_scc1 w2o_4
    s_lshl_b32 s27, s2, 9
    s_add_u32 s27, s27, 194816
    s_mov_b32 s26, 0
sp_6:
    s_load_dwordx16 s[56:71], s[50:51], s27 glc
    s_waitcnt lgkmcnt(0)
    s_xor_b32 s48, s56, s28
    s_xor_b32 s49, s57, s28
    s_or_b32 s48, s48, s49
    s_xor_b32 s49, s58, s28
    s_or_b32 s48, s48, s49
    s_xor_b32 s49, s59, s28
    s_or_b32 s48, s48, s49
    s_xor_b32 s49, s60, s28
    s_or_b32 s48, s48, s49
    s_xor_b32 s49, s61, s28
    s_or_b32 s48, s48, s49
    s_xor_b32 s49, s62, s28
    s_or_b32 s48, s48, s49
    s_xor_b32 s49, s63, s28
    s_or_b32 s48, s48, s49
    s_xor_b32 s49, s64, s28
    s_or_b32 s48, s48, s49
    s_xor_b32 s49, s65, s28
    s_or_b32 s48, s48, s49
    s_xor_b32 s49, s66, s28
    s_or_b32 s48, s48, s49
    s_xor_b32 s49, s67, s28
    s_or_b32 s48, s48, s49
    s_xor_b32 s49, s68, s28
    s_or_b32 s48, s48, s49
    s_xor_b32 s49, s69, s28
    s_or_b32 s48, s48, s49
    s_xor_b32 s49, s70, s28
    s_or_b32 s48, s48, s49
    s_xor_b32 s49, s71, s28
    s_or_b32 s48, s48, s49
    s_cmp_eq_u32 s48, 0
    s_cbranch_scc1 spd_7
    s_sleep 2
    s_add_u32 s26, s26, 1
    s_cmp_lt_u32 s26, 40000
    s_cbranch_scc1 sp_6
    v_mov_b32 v250, 4
    v_mov_b32 v251, 0xdead
    buffer_store_dword v251, v250, s[44:47], 0 offen sc1
spd_7:
    s_add_u32 s27, s27, 64
    s_mov_b32 s26, 0
sp_8:
    s_load_dwordx16 s[56:71], s[50:51], s27 glc
    s_waitcnt lgkmcnt(0)
    s_xor_b32 s48, s56, s28
    s_xor_b32 s49, s57, s28
    s_or_b32 s48, s48, s49
    s_xor_b32 s49, s58, s28
    s_or_b32 s48, s48, s49
    s_xor_b32 s49, s59, s28
    s_or_b32 s48, s48, s49
    s_xor_b32 s49, s60, s28
    s_or_b32 s48, s48, s49
    s_xor_b32 s49, s61, s28
    s_or_b32 s48, s48, s49
    s_xor_b32 s49, s62, s28
    s_or_b32 s48, s48, s49
    s_xor_b32 s49, s63, s28
    s_or_b32 s48, s48, s49
    s_xor_b32 s49, s64, s28
    s_or_b32 s48, s48, s49
    s_xor_b32 s49, s65, s28
    s_or_b32 s48, s48, s49
    s_xor_b32 s49, s66, s28
    s_or_b32 s48, s48, s49
    s_xor_b32 s49, s67, s28
    s_or_b32 s48, s48, s49
    s_xor_b32 s49, s68, s28
    s_or_b32 s48, s48, s49
    s_xor_b32 s49, s69, s28
    s_or_b32 s48, s48, s49
    s_xor_b32 s49, s70, s28
    s_or_b32 s48, s48, s49
    s_xor_b32 s49, s71, s28
    s_or_b32 s48, s48, s49
    s_cmp_eq_u32 s48, 0
    s_cbranch_scc1 spd_9
    s_sleep 2
    s_add_u32 s26, s26, 1
    s_cmp_lt_u32 s26, 40000
    s_cbranch_scc1 sp_8
    v_mov_b32 v250, 4
    v_mov_b32 v251, 0xdead
    buffer_store_dword v251, v250, s[44:47], 0 offen sc1
spd_9:
    s_add_u32 s27, s27, 64
    s_mov_b32 s26, 0
sp_10:
    s_load_dwordx16 s[56:71], s[50:51], s27 glc
    s_waitcnt lgkmcnt(0)
    s_xor_b32 s48, s56, s28
    s_xor_b32 s49, s57, s28
    s_or_b32 s48, s48, s49
    s_xor_b32 s49, s58, s28
    s_or_b32 s48, s48, s49
    s_xor_b32 s49, s59, s28
    s_or_b32 s48, s48, s49
    s_xor_b32 s49, s60, s28
    s_or_b32 s48, s48, s49
    s_xor_b32 s49, s61, s28
    s_or_b32 s48, s48, s49
    s_xor_b32 s49, s62, s28
    s_or_b32 s48, s48, s49
    s_xor_b32 s49, s63, s28
    s_or_b32 s48, s48, s49
    s_xor_b32 s49, s64, s28
    s_or_b32 s48, s48, s49
    s_xor_b32 s49, s65, s28
    s_or_b32 s48, s48, s49
    s_xor_b32 s49, s66, s28
    s_or_b32 s48, s48, s49
    s_xor_b32 s49, s67, s28
    s_or_b32 s48, s48, s49
    s_xor_b32 s49, s68, s28
    s_or_b32 s48, s48, s49
    s_xor_b32 s49, s69, s28
    s_or_b32 s48, s48, s49
    s_xor_b32 s49, s70, s28
    s_or_b32 s48, s48, s49
    s_xor_b32 s49, s71, s28
    s_or_b32 s48, s48, s49
    s_cmp_eq_u32 s48, 0
    s_cbranch_scc1 spd_11
    s_sleep 2
    s_add_u32 s26, s26, 1
    s_cmp_lt_u32 s26, 40000
    s_cbranch_scc1 sp_10
    v_mov_b32 v250, 4
    v_mov_b32 v251, 0xdead
    buffer_store_dword v251, v250, s[44:47], 0 offen sc1
spd_11:
    v_mov_b32 v24, 156676
    v_mov_b32 v25, 1
    s_mov_b64 s[48:49], exec
    s_mov_b64 exec, 1
    ds_write_b32 v24, v25
    s_mov_b64 exec, s[48:49]
    s_branch w2j_5
w2o_4:
    s_mov_b32 s26, 0
    v_mov_b32 v24, 156676
ldsw_12:
    ds_read_b32 v25, v24
    s_waitcnt lgkmcnt(0)
    v_readfirstlane_b32 s24, v25
    s_nop 3
    s_cmp_lg_u32 s24, 0
    s_cbranch_scc1 ldswd_13
    s_sleep 2
    s_add_u32 s26, s26, 1
    s_cmp_lt_u32 s26, 800000
    s_cbranch_scc1 ldsw_12
    v_mov_b32 v250, 4
    v_mov_b32 v251, 0xdead
    buffer_store_dword v251, v250, s[44:47], 0 offen sc1
ldswd_13:
w2j_5:
    buffer_load_dwordx4 v[120:123], v3, s[8:11], s33 offen offset:0 sc1
    buffer_load_dwordx4 v[124:127], v3, s[8:11], s33 offen offset:1024 sc1
    buffer_load_dwordx4 v[128:131], v3, s[8:11], s33 offen offset:2048 sc1
    buffer_load_dwordx4 v[132:135], v3, s[8:11], s33 offen offset:3072 sc1
    buffer_load_dwordx4 v[136:139], v4, s[8:11], s33 offen sc1
    s_add_u32 s33, s33, 5120
    buffer_load_dwordx4 v[156:159], v3, s[8:11], s33 offen offset:0 sc1
    buffer_load_dwordx4 v[160:163], v3, s[8:11], s33 offen offset:1024 sc1
    buffer_load_dwordx4 v[164:167], v3, s[8:11], s33 offen offset:2048 sc1
    buffer_load_dwordx4 v[168:171], v3, s[8:11], s33 offen offset:3072 sc1
    buffer_load_dwordx4 v[172:175], v4, s[8:11], s33 offen sc1
    s_add_u32 s33, s33, 5120
    buffer_load_dwordx4 v[192:195], v3, s[8:11], s33 offen offset:0 sc1
    buffer_load_dwordx4 v[196:199], v3, s[8:11], s33 offen offset:1024 sc1
    buffer_load_dwordx4 v[200:203], v3, s[8:11], s33 offen offset:2048 sc1
    buffer_load_dwordx4 v[204:207], v3, s[8:11], s33 offen offset:3072 sc1
    buffer_load_dwordx4 v[208:211], v4, s[8:11], s33 offen sc1
    s_add_u32 s33, s33, 5120
    buffer_load_dwordx4 v[228:231], v3, s[8:11], s33 offen offset:0 sc1
    buffer_load_dwordx4 v[232:235], v3, s[8:11], s33 offen offset:1024 sc1
    buffer_load_dwordx4 v[236:239], v3, s[8:11], s33 offen offset:2048 sc1
    buffer_load_dwordx4 v[240:243], v3, s[8:11], s33 offen offset:3072 sc1
    buffer_load_dwordx4 v[244:247], v4, s[8:11], s33 offen sc1
    s_add_u32 s33, s33, 5120
    s_branch L_gemm2
L_g1prod:
    s_sub_u32 s27, s29, 4
    v_and_b32 v2, 63, v0
    v_lshrrev_b32 v3, 3, v2
    v_and_b32 v4, 7, v2
    s_lshl_b32 s24, s27, 5
    s_movk_i32 s25, 1280
    v_add_u32 v5, s24, v3
    v_bfe_u32 v6, v5, 1, 3
    v_xor_b32 v6, v6, v4
    v_lshlrev_b32 v6, 4, v6
    v_mul_lo_u32 v7, v5, s25
    v_add_u32 v10, v7, v6
    v_add_u32 v5, s24, v3
    v_add_u32 v5, 8, v5
    v_bfe_u32 v6, v5, 1, 3
    v_xor_b32 v6, v6, v4
    v_lshlrev_b32 v6, 4, v6
    v_mul_lo_u32 v7, v5, s25
    v_add_u32 v11, v7, v6
    v_add_u32 v5, s24, v3
    v_add_u32 v5, 16, v5
    v_bfe_u32 v6, v5, 1, 3
    v_xor_b32 v6, v6, v4
    v_lshlrev_b32 v6, 4, v6
    v_mul_lo_u32 v7, v5, s25
    v_add_u32 v12, v7, v6
    v_add_u32 v5, s24, v3
    v_add_u32 v5, 24, v5
    v_bfe_u32 v6, v5, 1, 3
    v_xor_b32 v6, v6, v4
    v_lshlrev_b32 v6, 4, v6
    v_mul_lo_u32 v7, v5, s25
    v_add_u32 v13, v7, v6
    v_lshrrev_b32 v3, 4, v2
    v_and_b32 v4, 15, v2
    v_lshlrev_b32 v6, 2, v3
    v_xor_b32 v6, v6, v4
    v_lshlrev_b32 v6, 4, v6
    s_lshl_b32 s24, s27, 4
    s_movk_i32 s25, 3072
    v_add_u32 v5, s24, v3
    v_mul_lo_u32 v7, v5, s25
    v_add_u32 v14, v7, v6
    v_add_u32 v5, s24, v3
    v_add_u32 v5, 4, v5
    v_mul_lo_u32 v7, v5, s25
    v_add_u32 v15, v7, v6
    v_add_u32 v5, s24, v3
    v_add_u32 v5, 8, v5
    v_mul_lo_u32 v7, v5, s25
    v_add_u32 v16, v7, v6
    v_add_u32 v5, s24, v3
    v_add_u32 v5, 12, v5
    v_mul_lo_u32 v7, v5, s25
    v_add_u32 v17, v7, v6
    s_mul_i32 s32, s30, 163840
    s_lshl_b32 s33, s31, 8
    s_lshl_b32 s34, s27, 12
    s_waitcnt lgkmcnt(0)
    s_mov_b64 s[4:5], s[72:73]
    s_and_b32 s5, s5, 0xffff
    s_mov_b32 s6, 2621440
    s_mov_b32 s7, 0x00020000
    s_mov_b64 s[8:9], s[86:87]
    s_and_b32 s9, s9, 0xffff
    s_mov_b32 s10, 1966080
    s_mov_b32 s11, 0x00020000
    s_mul_i32 s35, s30, 3
    s_add_u32 s35, s35, s31
    s_mul_hi_u32 s36, s35, 0x1999999A
    s_mul_i32 s36, s36, 10
    s_sub_u32 s35, s35, s36
    s_lshl_b32 s36, s35, 7
    s_add_u32 s32, s32, s36
    s_mul_i32 s36, s35, 196608
    s_add_u32 s33, s33, s36
    s_add_u32 m0, s34, 0
    s_nop 0
    buffer_load_dwordx4 v10, s[4:7], s32 offen lds
    s_add_u32 m0, s34, 16384
    s_nop 0
    buffer_load_dwordx4 v14, s[8:11], s33 offen lds
    s_add_u32 m0, s34, 1024
    s_nop 0
    buffer_load_dwordx4 v11, s[4:7], s32 offen lds
    s_add_u32 m0, s34, 17408
    s_nop 0
    buffer_load_dwordx4 v15, s[8:11], s33 offen lds
    s_add_u32 m0, s34, 2048
    s_nop 0
    buffer_load_dwordx4 v12, s[4:7], s32 offen lds
    s_add_u32 m0, s34, 18432
    s_nop 0
    buffer_load_dwordx4 v16, s[8:11], s33 offen lds
    s_add_u32 m0, s34, 3072
    s_nop 0
    buffer_load_dwordx4 v13, s[4:7], s32 offen lds
    s_add_u32 m0, s34, 19456
    s_nop 0
    buffer_load_dwordx4 v17, s[8:11], s33 offen lds
    s_add_u32 s32, s32, 128
    s_add_u32 s33, s33, 196608
    s_add_u32 s35, s35, 1
    s_cmp_eq_u32 s35, 10
    s_cselect_b32 s36, 1280, 0
    s_sub_u32 s32, s32, s36
    s_cmp_eq_u32 s35, 10
    s_cselect_b32 s36, 1966080, 0
    s_sub_u32 s33, s33, s36
    s_cmp_eq_u32 s35, 10
    s_cselect_b32 s35, 0, s35
    s_add_u32 m0, s34, 32768
    s_nop 0
    buffer_load_dwordx4 v10, s[4:7], s32 offen lds
    s_add_u32 m0, s34, 49152
    s_nop 0
    buffer_load_dwordx4 v14, s[8:11], s33 offen lds
    s_add_u32 m0, s34, 33792
    s_nop 0
    buffer_load_dwordx4 v11, s[4:7], s32 offen lds
    s_add_u32 m0, s34, 50176
    s_nop 0
    buffer_load_dwordx4 v15, s[8:11], s33 offen lds
    s_add_u32 m0, s34, 34816
    s_nop 0
    buffer_load_dwordx4 v12, s[4:7], s32 offen lds
    s_add_u32 m0, s34, 51200
    s_nop 0
    buffer_load_dwordx4 v16, s[8:11], s33 offen lds
    s_add_u32 m0, s34, 35840
    s_nop 0
    buffer_load_dwordx4 v13, s[4:7], s32 offen lds
    s_add_u32 m0, s34, 52224
    s_nop 0
    buffer_load_dwordx4 v17, s[8:11], s33 offen lds
    s_add_u32 s32, s32, 128
    s_add_u32 s33, s33, 196608
    s_add_u32 s35, s35, 1
    s_cmp_eq_u32 s35, 10
    s_cselect_b32 s36, 1280, 0
    s_sub_u32 s32, s32, s36
    s_cmp_eq_u32 s35, 10
    s_cselect_b32 s36, 1966080, 0
    s_sub_u32 s33, s33, s36
    s_cmp_eq_u32 s35, 10
    s_cselect_b32 s35, 0, s35
    s_mov_b64 s[12:13], s[88:89]
    s_and_b32 s13, s13, 0xffff
    s_mov_b32 s14, 3072
    s_mov_b32 s15, 0x00020000
    s_mov_b64 s[16:17], s[98:99]
    s_add_u32 s16, s16, 13500416
    s_addc_u32 s17, s17, 0
    s_and_b32 s17, s17, 0xffff
    s_mov_b32 s18, 16384
    s_mov_b32 s19, 0x00020000
    s_mov_b64 s[20:21], s[98:99]
    s_add_u32 s20, s20, 13516800
    s_addc_u32 s21, s21, 0
    s_and_b32 s21, s21, 0xffff
    s_mov_b32 s22, 98304
    s_mov_b32 s23, 0x00020000
    s_waitcnt lgkmcnt(0)
    s_add_u32 s50, s98, 13615104
    s_addc_u32 s51, s99, 0
    s_mov_b32 s48, 325632
    s_load_dword s28, s[50:51], s48
    s_mov_b64 s[40:41], s[98:99]
    s_add_u32 s40, s40, 13615104
    s_addc_u32 s41, s41, 0
    s_and_b32 s41, s41, 0xffff
    s_mov_b32 s42, 325760
    s_mov_b32 s43, 0x00020000
    s_mov_b64 s[44:45], s[96:97]
    s_and_b32 s45, s45, 0xffff
    s_mov_b32 s46, 256
    s_mov_b32 s47, 0x00020000
    s_waitcnt lgkmcnt(0)
    s_add_u32 s28, s28, 1
    v_and_b32 v8, 31, v2
    s_lshl_b32 s24, s2, 9
    s_add_u32 s69, s24, 195024
    s_lshl_b32 s25, s27, 2
    s_add_u32 s24, s24, s25
    s_add_u32 s68, s24, 195008
    s_lshl_b32 s24, s30, 7
    s_lshl_b32 s25, s27, 5
    s_add_u32 s24, s24, s25
    v_add_u32 v26, s24, v8
    v_lshlrev_b32 v26, 3, v26
    s_mul_i32 s38, s31, 5120
    s_lshl_b32 s25, s27, 7
    s_add_u32 s38, s38, s25
    v_lshlrev_b32 v27, 2, v8
    s_lshl_b32 s24, s31, 7
    s_lshl_b32 s25, s27, 5
    s_add_u32 s24, s24, s25
    v_add_u32 v28, s24, v8
    v_lshlrev_b32 v28, 1, v28
    s_mov_b32 s39, 0
    s_mov_b64 s[52:53], s[90:91]
    s_and_b32 s53, s53, 0xffff
    s_mov_b32 s54, 1966080
    s_mov_b32 s55, 0x00020000
    s_lshl_b32 s24, s27, 6
    s_add_u32 s24, s24, 0
    v_add_u32 v50, s24, v2
    v_mul_u32_u24 v51, 3277, v50
    v_lshrrev_b32 v51, 16, v51
    v_mul_u32_u24 v52, 20, v51
    v_sub_u32 v52, v50, v52
    v_mul_u32_u24 v51, 1280, v51
    v_lshl_add_u32 v53, v52, 4, v51
    s_lshl_b32 s24, s27, 6
    s_add_u32 s24, s24, 256
    v_add_u32 v50, s24, v2
    v_mul_u32_u24 v51, 3277, v50
    v_lshrrev_b32 v51, 16, v51
    v_mul_u32_u24 v52, 20, v51
    v_sub_u32 v52, v50, v52
    v_mul_u32_u24 v51, 1280, v51
    v_lshl_add_u32 v54, v52, 4, v51
    s_lshl_b32 s24, s27, 6
    s_add_u32 s24, s24, 512
    v_add_u32 v50, s24, v2
    v_mul_u32_u24 v51, 3277, v50
    v_lshrrev_b32 v51, 16, v51
    v_mul_u32_u24 v52, 20, v51
    v_sub_u32 v52, v50, v52
    v_mul_u32_u24 v51, 1280, v51
    v_lshl_add_u32 v55, v52, 4, v51
    s_lshr_b32 s37, s2, 2
    s_mul_i32 s37, s37, 40960
    s_and_b32 s24, s2, 3
    s_mul_i32 s24, s24, 320
    s_add_u32 s37, s37, s24
    s_waitcnt vmcnt(8)
    s_barrier
    s_add_u32 m0, s34, 65536
    s_nop 0
    buffer_load_dwordx4 v10, s[4:7], s32 offen lds
    s_add_u32 m0, s34, 81920
    s_nop 0
    buffer_load_dwordx4 v14, s[8:11], s33 offen lds
    s_add_u32 m0, s34, 66560
    s_nop 0
    buffer_load_dwordx4 v11, s[4:7], s32 offen lds
    s_add_u32 m0, s34, 82944
    s_nop 0
    buffer_load_dwordx4 v15, s[8:11], s33 offen lds
    s_add_u32 m0, s34, 67584
    s_nop 0
    buffer_load_dwordx4 v12, s[4:7], s32 offen lds
    s_add_u32 m0, s34, 83968
    s_nop 0
    buffer_load_dwordx4 v16, s[8:11], s33 offen lds
    s_add_u32 m0, s34, 68608
    s_nop 0
    buffer_load_dwordx4 v13, s[4:7], s32 offen lds
    s_add_u32 m0, s34, 84992
    s_nop 0
    buffer_load_dwordx4 v17, s[8:11], s33 offen lds
    s_add_u32 s32, s32, 128
    s_add_u32 s33, s33, 196608
    s_add_u32 s35, s35, 1
    s_cmp_eq_u32 s35, 10
    s_cselect_b32 s36, 1280, 0
    s_sub_u32 s32, s32, s36
    s_cmp_eq_u32 s35, 10
    s_cselect_b32 s36, 1966080, 0
    s_sub_u32 s33, s33, s36
    s_cmp_eq_u32 s35, 10
    s_cselect_b32 s35, 0, s35
    s_waitcnt vmcnt(8)
    s_barrier
    s_add_u32 m0, s34, 98304
    s_nop 0
    buffer_load_dwordx4 v10, s[4:7], s32 offen lds
    s_add_u32 m0, s34, 114688
    s_nop 0
    buffer_load_dwordx4 v14, s[8:11], s33 offen lds
    s_add_u32 m0, s34, 99328
    s_nop 0
    buffer_load_dwordx4 v11, s[4:7], s32 offen lds
    s_add_u32 m0, s34, 115712
    s_nop 0
    buffer_load_dwordx4 v15, s[8:11], s33 offen lds
    s_add_u32 m0, s34, 100352
    s_nop 0
    buffer_load_dwordx4 v12, s[4:7], s32 offen lds
    s_add_u32 m0, s34, 116736
    s_nop 0
    buffer_load_dwordx4 v16, s[8:11], s33 offen lds
    s_add_u32 m0, s34, 101376
    s_nop 0
    buffer_load_dwordx4 v13, s[4:7], s32 offen lds
    s_add_u32 m0, s34, 117760
    s_nop 0
    buffer_load_dwordx4 v17, s[8:11], s33 offen lds
    s_add_u32 s32, s32, 128
    s_add_u32 s33, s33, 196608
    s_add_u32 s35, s35, 1
    s_cmp_eq_u32 s35, 10
    s_cselect_b32 s36, 1280, 0
    s_sub_u32 s32, s32, s36
    s_cmp_eq_u32 s35, 10
    s_cselect_b32 s36, 1966080, 0
    s_sub_u32 s33, s33, s36
    s_cmp_eq_u32 s35, 10
    s_cselect_b32 s35, 0, s35
    s_lshl_b32 s24, s27, 10
    s_add_u32 m0, s24, 139264
    s_nop 0
    buffer_load_dwordx4 v53, s[52:55], s37 offen nt lds
    s_lshl_b32 s24, s27, 10
    s_add_u32 m0, s24, 143360
    s_nop 0
    buffer_load_dwordx4 v54, s[52:55], s37 offen nt lds
    s_lshl_b32 s24, s27, 10
    s_add_u32 m0, s24, 147456
    s_nop 0
    buffer_load_dwordx4 v55, s[52:55], s37 offen nt lds
    s_waitcnt vmcnt(11)
    s_barrier
    s_add_u32 m0, s34, 0
    s_nop 0
    buffer_load_dwordx4 v10, s[4:7], s32 offen lds
    s_add_u32 m0, s34, 16384
    s_nop 0
    buffer_load_dwordx4 v14, s[8:11], s33 offen lds
    s_add_u32 m0, s34, 1024
    s_nop 0
    buffer_load_dwordx4 v11, s[4:7], s32 offen lds
    s_add_u32 m0, s34, 17408
    s_nop 0
    buffer_load_dwordx4 v15, s[8:11], s33 offen lds
    s_add_u32 m0, s34, 2048
    s_nop 0
    buffer_load_dwordx4 v12, s[4:7], s32 offen lds
    s_add_u32 m0, s34, 18432
    s_nop 0
    buffer_load_dwordx4 v16, s[8:11], s33 offen lds
    s_add_u32 m0, s34, 3072
    s_nop 0
    buffer_load_dwordx4 v13, s[4:7], s32 offen lds
    s_add_u32 m0, s34, 19456
    s_nop 0
    buffer_load_dwordx4 v17, s[8:11], s33 offen lds
    s_add_u32 s32, s32, 128
    s_add_u32 s33, s33, 196608
    s_add_u32 s35, s35, 1
    s_cmp_eq_u32 s35, 10
    s_cselect_b32 s36, 1280, 0
    s_sub_u32 s32, s32, s36
    s_cmp_eq_u32 s35, 10
    s_cselect_b32 s36, 1966080, 0
    s_sub_u32 s33, s33, s36
    s_cmp_eq_u32 s35, 10
    s_cselect_b32 s35, 0, s35
    s_waitcnt vmcnt(11)
    s_barrier
    s_add_u32 m0, s34, 32768
    s_nop 0
    buffer_load_dwordx4 v10, s[4:7], s32 offen lds
    s_add_u32 m0, s34, 49152
    s_nop 0
    buffer_load_dwordx4 v14, s[8:11], s33 offen lds
    s_add_u32 m0, s34, 33792
    s_nop 0
    buffer_load_dwordx4 v11, s[4:7], s32 offen lds
    s_add_u32 m0, s34, 50176
    s_nop 0
    buffer_load_dwordx4 v15, s[8:11], s33 offen lds
    s_add_u32 m0, s34, 34816
    s_nop 0
    buffer_load_dwordx4 v12, s[4:7], s32 offen lds
    s_add_u32 m0, s34, 51200
    s_nop 0
    buffer_load_dwordx4 v16, s[8:11], s33 offen lds
    s_add_u32 m0, s34, 35840
    s_nop 0
    buffer_load_dwordx4 v13, s[4:7], s32 offen lds
    s_add_u32 m0, s34, 52224
    s_nop 0
    buffer_load_dwordx4 v17, s[8:11], s33 offen lds
    s_add_u32 s32, s32, 128
    s_add_u32 s33, s33, 196608
    s_add_u32 s35, s35, 1
    s_cmp_eq_u32 s35, 10
    s_cselect_b32 s36, 1280, 0
    s_sub_u32 s32, s32, s36
    s_cmp_eq_u32 s35, 10
    s_cselect_b32 s36, 1966080, 0
    s_sub_u32 s33, s33, s36
    s_cmp_eq_u32 s35, 10
    s_cselect_b32 s35, 0, s35
    s_waitcnt vmcnt(8)
    s_barrier
    s_add_u32 m0, s34, 65536
    s_nop 0
    buffer_load_dwordx4 v10, s[4:7], s32 offen lds
    s_add_u32 m0, s34, 81920
    s_nop 0
    buffer_load_dwordx4 v14, s[8:11], s33 offen lds
    s_add_u32 m0, s34, 66560
    s_nop 0
    buffer_load_dwordx4 v11, s[4:7], s32 offen lds
    s_add_u32 m0, s34, 82944
    s_nop 0
    buffer_load_dwordx4 v15, s[8:11], s33 offen lds
    s_add_u32 m0, s34, 67584
    s_nop 0
    buffer_load_dwordx4 v12, s[4:7], s32 offen lds
    s_add_u32 m0, s34, 83968
    s_nop 0
    buffer_load_dwordx4 v16, s[8:11], s33 offen lds
    s_add_u32 m0, s34, 68608
    s_nop 0
    buffer_load_dwordx4 v13, s[4:7], s32 offen lds
    s_add_u32 m0, s34, 84992
    s_nop 0
    buffer_load_dwordx4 v17, s[8:11], s33 offen lds
    s_add_u32 s32, s32, 128
    s_add_u32 s33, s33, 196608
    s_add_u32 s35, s35, 1
    s_cmp_eq_u32 s35, 10
    s_cselect_b32 s36, 1280, 0
    s_sub_u32 s32, s32, s36
    s_cmp_eq_u32 s35, 10
    s_cselect_b32 s36, 1966080, 0
    s_sub_u32 s33, s33, s36
    s_cmp_eq_u32 s35, 10
    s_cselect_b32 s35, 0, s35
    s_waitcnt vmcnt(8)
    s_barrier
    s_add_u32 m0, s34, 98304
    s_nop 0
    buffer_load_dwordx4 v10, s[4:7], s32 offen lds
    s_add_u32 m0, s34, 114688
    s_nop 0
    buffer_load_dwordx4 v14, s[8:11], s33 offen lds
    s_add_u32 m0, s34, 99328
    s_nop 0
    buffer_load_dwordx4 v11, s[4:7], s32 offen lds
    s_add_u32 m0, s34, 115712
    s_nop 0
    buffer_load_dwordx4 v15, s[8:11], s33 offen lds
    s_add_u32 m0, s34, 100352
    s_nop 0
    buffer_load_dwordx4 v12, s[4:7], s32 offen lds
    s_add_u32 m0, s34, 116736
    s_nop 0
    buffer_load_dwordx4 v16, s[8:11], s33 offen lds
    s_add_u32 m0, s34, 101376
    s_nop 0
    buffer_load_dwordx4 v13, s[4:7], s32 offen lds
    s_add_u32 m0, s34, 117760
    s_nop 0
    buffer_load_dwordx4 v17, s[8:11], s33 offen lds
    s_add_u32 s32, s32, 128
    s_add_u32 s33, s33, 196608
    s_add_u32 s35, s35, 1
    s_cmp_eq_u32 s35, 10
    s_cselect_b32 s36, 1280, 0
    s_sub_u32 s32, s32, s36
    s_cmp_eq_u32 s35, 10
    s_cselect_b32 s36, 1966080, 0
    s_sub_u32 s33, s33, s36
    s_cmp_eq_u32 s35, 10
    s_cselect_b32 s35, 0, s35
    s_waitcnt vmcnt(8)
    s_barrier
    s_add_u32 m0, s34, 0
    s_nop 0
    buffer_load_dwordx4 v10, s[4:7], s32 offen lds
    s_add_u32 m0, s34, 16384
    s_nop 0
    buffer_load_dwordx4 v14, s[8:11], s33 offen lds
    s_add_u32 m0, s34, 1024
    s_nop 0
    buffer_load_dwordx4 v11, s[4:7], s32 offen lds
    s_add_u32 m0, s34, 17408
    s_nop 0
    buffer_load_dwordx4 v15, s[8:11], s33 offen lds
    s_add_u32 m0, s34, 2048
    s_nop 0
    buffer_load_dwordx4 v12, s[4:7], s32 offen lds
    s_add_u32 m0, s34, 18432
    s_nop 0
    buffer_load_dwordx4 v16, s[8:11], s33 offen lds
    s_add_u32 m0, s34, 3072
    s_nop 0
    buffer_load_dwordx4 v13, s[4:7], s32 offen lds
    s_add_u32 m0, s34, 19456
    s_nop 0
    buffer_load_dwordx4 v17, s[8:11], s33 offen lds
    s_add_u32 s32, s32, 128
    s_add_u32 s33, s33, 196608
    s_add_u32 s35, s35, 1
    s_cmp_eq_u32 s35, 10
    s_cselect_b32 s36, 1280, 0
    s_sub_u32 s32, s32, s36
    s_cmp_eq_u32 s35, 10
    s_cselect_b32 s36, 1966080, 0
    s_sub_u32 s33, s33, s36
    s_cmp_eq_u32 s35, 10
    s_cselect_b32 s35, 0, s35
    s_waitcnt vmcnt(8)
    s_barrier
    s_add_u32 m0, s34, 32768
    s_nop 0
    buffer_load_dwordx4 v10, s[4:7], s32 offen lds
    s_add_u32 m0, s34, 49152
    s_nop 0
    buffer_load_dwordx4 v14, s[8:11], s33 offen lds
    s_add_u32 m0, s34, 33792
    s_nop 0
    buffer_load_dwordx4 v11, s[4:7], s32 offen lds
    s_add_u32 m0, s34, 50176
    s_nop 0
    buffer_load_dwordx4 v15, s[8:11], s33 offen lds
    s_add_u32 m0, s34, 34816
    s_nop 0
    buffer_load_dwordx4 v12, s[4:7], s32 offen lds
    s_add_u32 m0, s34, 51200
    s_nop 0
    buffer_load_dwordx4 v16, s[8:11], s33 offen lds
    s_add_u32 m0, s34, 35840
    s_nop 0
    buffer_load_dwordx4 v13, s[4:7], s32 offen lds
    s_add_u32 m0, s34, 52224
    s_nop 0
    buffer_load_dwordx4 v17, s[8:11], s33 offen lds
    s_add_u32 s32, s32, 128
    s_add_u32 s33, s33, 196608
    s_add_u32 s35, s35, 1
    s_cmp_eq_u32 s35, 10
    s_cselect_b32 s36, 1280, 0
    s_sub_u32 s32, s32, s36
    s_cmp_eq_u32 s35, 10
    s_cselect_b32 s36, 1966080, 0
    s_sub_u32 s33, s33, s36
    s_cmp_eq_u32 s35, 10
    s_cselect_b32 s35, 0, s35
    s_load_dword s56, s[50:51], s68 glc
    s_load_dwordx8 s[60:67], s[50:51], s69 glc
    s_waitcnt vmcnt(8)
    s_barrier
    s_waitcnt lgkmcnt(0)
    s_xor_b32 s48, s56, s28
    s_xor_b32 s49, s60, s28
    s_or_b32 s48, s48, s49
    s_xor_b32 s49, s61, s28
    s_or_b32 s48, s48, s49
    s_xor_b32 s49, s62, s28
    s_or_b32 s48, s48, s49
    s_xor_b32 s49, s63, s28
    s_or_b32 s48, s48, s49
    s_xor_b32 s49, s64, s28
    s_or_b32 s48, s48, s49
    s_cmp_eq_u32 s48, 0
    s_cbranch_scc0 noext_14
    buffer_load_dwordx2 v[30:31], v26, s[16:19], 0 offen sc1
    buffer_load_dword v60, v27, s[20:23], s38 offen offset:0 sc1
    buffer_load_dword v61, v27, s[20:23], s38 offen offset:512 sc1
    buffer_load_dword v62, v27, s[20:23], s38 offen offset:1024 sc1
    buffer_load_dword v63, v27, s[20:23], s38 offen offset:1536 sc1
    buffer_load_dword v64, v27, s[20:23], s38 offen offset:2048 sc1
    buffer_load_ushort v45, v28, s[12:15], 0 offen
    s_mov_b32 s39, 1
noext_14:
    s_lshl_b32 s24, s2, 2
    s_add_u32 s24, s24, s27
    s_min_u32 s24, s24, 639
    s_lshl_b32 s25, s24, 12
    s_lshl_b32 s24, s24, 1
    v_mov_b32 v93, s24
    v_and_b32 v92, 63, v0
    v_lshlrev_b32 v95, 4, v92
    s_waitcnt lgkmcnt(0)
    s_mov_b64 s[4:5], s[80:81]
    s_add_u32 s4, s4, s25
    s_addc_u32 s5, s5, 0
    s_and_b32 s5, s5, 0xffff
    s_mov_b32 s6, 4096
    s_mov_b32 s7, 0x00020000
    s_mov_b64 s[8:9], s[82:83]
    s_and_b32 s9, s9, 0xffff
    s_mov_b32 s10, 1280
    s_mov_b32 s11, 0x00020000
    s_cmp_ge_u32 s2, 160
    s_cselect_b32 s6, 0, s6
    s_cselect_b32 s10, 0, s10
    buffer_load_ushort v94, v93, s[8:11], 0 offen
    buffer_load_dwordx4 v[100:103], v95, s[4:7], 0 offen offset:0 nt
    buffer_load_dwordx4 v[104:107], v95, s[4:7], 0 offen offset:1024 nt
    buffer_load_dwordx4 v[108:111], v95, s[4:7], 0 offen offset:2048 nt
    buffer_load_dwordx4 v[112:115], v95, s[4:7], 0 offen offset:3072 nt
    s_cmp_eq_u32 s39, 0
    s_cbranch_scc1 c9a_15
    s_waitcnt vmcnt(12)
    s_branch c9b_16
c9a_15:
    s_waitcnt vmcnt(5)
c9b_16:
    s_barrier
    s_cmp_lg_u32 s39, 0
    s_cbranch_scc1 extfast_17
    s_mov_b32 s26, 0
sp_18:
    s_load_dword s56, s[50:51], s68 glc
    s_load_dwordx8 s[60:67], s[50:51], s69 glc
    s_waitcnt lgkmcnt(0)
    s_xor_b32 s48, s56, s28
    s_xor_b32 s49, s60, s28
    s_or_b32 s48, s48, s49
    s_xor_b32 s49, s61, s28
    s_or_b32 s48, s48, s49
    s_xor_b32 s49, s62, s28
    s_or_b32 s48, s48, s49
    s_xor_b32 s49, s63, s28
    s_or_b32 s48, s48, s49
    s_xor_b32 s49, s64, s28
    s_or_b32 s48, s48, s49
    s_cmp_eq_u32 s48, 0
    s_cbranch_scc1 spd_19
    s_sleep 1
    s_add_u32 s26, s26, 1
    s_cmp_lt_u32 s26, 40000
    s_cbranch_scc1 sp_18
    v_mov_b32 v250, 4
    v_mov_b32 v251, 0xdead
    buffer_store_dword v251, v250, s[44:47], 0 offen sc1
spd_19:
    buffer_load_dwordx2 v[30:31], v26, s[16:19], 0 offen sc1
    buffer_load_dword v60, v27, s[20:23], s38 offen offset:0 sc1
    buffer_load_dword v61, v27, s[20:23], s38 offen offset:512 sc1
    buffer_load_dword v62, v27, s[20:23], s38 offen offset:1024 sc1
    buffer_load_dword v63, v27, s[20:23], s38 offen offset:1536 sc1
    buffer_load_dword v64, v27, s[20:23], s38 offen offset:2048 sc1
    buffer_load_ushort v45, v28, s[12:15], 0 offen
    s_waitcnt vmcnt(0)
extfast_17:
    s_waitcnt vmcnt(5)
    v_and_b32 v40, 0xffff, v30
    v_xor_b32 v40, 0x8000, v40
    v_lshl_or_b32 v40, v40, 16, v40
    v_lshrrev_b32 v41, 16, v30
    v_mov_b32 v42, 0
    v_mov_b32 v43, 0
    v_add_f32 v60, v60, v61
    v_add_f32 v62, v62, v63
    v_add_f32 v60, v60, v62
    v_add_f32 v60, v60, v64
    v_mov_b32 v32, v60
    v_cvt_pk_bf16_f32 v44, v32, v32
    v_and_b32 v46, 0xffff0000, v44
    v_sub_f32 v46, v32, v46
    v_cvt_pk_bf16_f32 v44, v32, v46
    v_mov_b32 v46, 0
    v_mov_b32 v47, 0
    v_cmp_gt_u32 vcc, 32, v2
    s_nop 1
    v_cndmask_b32 v40, 0, v40, vcc
    v_cndmask_b32 v41, 0, v41, vcc
    v_cndmask_b32 v44, 0, v44, vcc
    v_cndmask_b32 v45, 0, v45, vcc
    v_lshlrev_b32 v48, 4, v2
    s_lshl_b32 s24, s27, 10
    s_add_u32 s24, s24, 131072
    v_add_u32 v48, s24, v48
    ds_write_b128 v48, v[44:47]
    ds_write_b128 v48, v[40:43] offset:4096
    s_waitcnt lgkmcnt(0)
    s_barrier
    s_branch L_convsel
L_helper:
    s_sub_u32 s30, s2, 192
    v_and_b32 v2, 63, v0
    s_cmp_eq_u32 s29, 7
    s_cbranch_scc1 L_hiss
    s_cmp_ge_u32 s29, 4
    s_cbranch_scc1 L_hpre
    v_lshrrev_b32 v3, 4, v2
    v_and_b32 v4, 15, v2
    s_and_b32 s24, s30, 7
    s_lshr_b32 s25, s30, 3
    s_lshr_b32 s26, s24, 1
    s_and_b32 s24, s24, 1
    s_lshl_b32 s31, s26, 4
    s_lshl_b32 s27, s24, 3
    s_add_u32 s31, s31, s27
    s_add_u32 s31, s31, s25
    s_lshl_b32 s21, s26, 3
    s_add_u32 s21, s21, s25
    s_mul_i32 s20, s24, 6
    s_lshl_b32 s24, s31, 5
    s_lshl_b32 s25, s29, 3
    s_add_u32 s24, s24, s25
    v_add_u32 v5, s24, v3
    s_movk_i32 s25, 1280
    v_mul_lo_u32 v6, v5, s25
    v_lshl_add_u32 v6, v4, 4, v6
    v_add_u32 v7, 5120, v6
    s_mul_hi_u32 s32, s21, 0x33333334
    s_mul_i32 s33, s32, 5
    s_sub_u32 s33, s21, s33
    s_add_u32 s32, s32, s20
    s_lshl_b32 s24, s33, 7
    s_lshl_b32 s25, s29, 5
    s_add_u32 s24, s24, s25
    v_add_u32 v8, s24, v3
    s_movk_i32 s25, 3072
    v_mul_lo_u32 v8, v8, s25
    v_lshl_add_u32 v8, v4, 4, v8
    s_lshl_b32 s34, s32, 8
    s_waitcnt lgkmcnt(0)
    s_mov_b64 s[4:5], s[72:73]
    s_and_b32 s5, s5, 0xffff
    s_mov_b32 s6, 2621440
    s_mov_b32 s7, 0x00020000
    s_mov_b64 s[8:9], s[86:87]
    s_and_b32 s9, s9, 0xffff
    s_mov_b32 s10, 1966080
    s_mov_b32 s11, 0x00020000
    buffer_load_dwordx4 v[16:19], v6, s[4:7], 0 offen offset:0
    buffer_load_dwordx4 v[20:23], v6, s[4:7], 0 offen offset:256
    buffer_load_dwordx4 v[24:27], v6, s[4:7], 0 offen offset:512
    buffer_load_dwordx4 v[28:31], v6, s[4:7], 0 offen offset:768
    buffer_load_dwordx4 v[32:35], v6, s[4:7], 0 offen offset:1024
    buffer_load_dwordx4 v[36:39], v7, s[4:7], 0 offen offset:0
    buffer_load_dwordx4 v[40:43], v7, s[4:7], 0 offen offset:256
    buffer_load_dwordx4 v[44:47], v7, s[4:7], 0 offen offset:512
    buffer_load_dwordx4 v[48:51], v7, s[4:7], 0 offen offset:768
    buffer_load_dwordx4 v[52:55], v7, s[4:7], 0 offen offset:1024
    s_add_u32 s35, s34, 0
    buffer_load_dwordx4 v[56:59], v8, s[8:11], s35 offen
    s_add_u32 s35, s34, 12288
    buffer_load_dwordx4 v[60:63], v8, s[8:11], s35 offen
    s_add_u32 s35, s34, 24576
    buffer_load_dwordx4 v[64:67], v8, s[8:11], s35 offen
    s_add_u32 s35, s34, 36864
    buffer_load_dwordx4 v[68:71], v8, s[8:11], s35 offen
    s_add_u32 s35, s34, 49152
    buffer_load_dwordx4 v[72:75], v8, s[8:11], s35 offen
    s_add_u32 s35, s34, 61440
    buffer_load_dwordx4 v[76:79], v8, s[8:11], s35 offen
    s_add_u32 s35, s34, 73728
    buffer_load_dwordx4 v[80:83], v8, s[8:11], s35 offen
    s_add_u32 s35, s34, 86016
    buffer_load_dwordx4 v[84:87], v8, s[8:11], s35 offen
    s_barrier
    s_mov_b64 s[12:13], s[98:99]
    s_add_u32 s12, s12, 13500416
    s_addc_u32 s13, s13, 0
    s_and_b32 s13, s13, 0xffff
    s_mov_b32 s14, 16384
    s_mov_b32 s15, 0x00020000
    s_mov_b64 s[16:17], s[98:99]
    s_add_u32 s16, s16, 13516800
    s_addc_u32 s17, s17, 0
    s_and_b32 s17, s17, 0xffff
    s_mov_b32 s18, 98304
    s_mov_b32 s19, 0x00020000
    s_waitcnt lgkmcnt(0)
    s_add_u32 s50, s98, 13615104
    s_addc_u32 s51, s99, 0
    s_mov_b32 s48, 325632
    s_load_dword s28, s[50:51], s48
    s_mov_b64 s[40:41], s[98:99]
    s_add_u32 s40, s40, 13615104
    s_addc_u32 s41, s41, 0
    s_and_b32 s41, s41, 0xffff
    s_mov_b32 s42, 325760
    s_mov_b32 s43, 0x00020000
    s_mov_b64 s[44:45], s[96:97]
    s_and_b32 s45, s45, 0xffff
    s_mov_b32 s46, 256
    s_mov_b32 s47, 0x00020000
    s_waitcnt lgkmcnt(0)
    s_add_u32 s28, s28, 1
    s_mov_b32 s39, 0x3f803f80
    s_waitcnt vmcnt(8)
    v_mov_b32 v98, 156692
    v_mov_b32 v99, 1
    s_mov_b64 s[48:49], exec
    s_mov_b64 exec, 1
    ds_write_b32 v98, v99
    s_mov_b64 exec, s[48:49]
    v_mov_b32 v90, 0
    v_mov_b32 v91, 0
    v_mov_b32 v92, 0
    v_mov_b32 v93, 0
    v_dot2_f32_bf16 v90, v16, s39, v90
    v_dot2_f32_bf16 v91, v16, v16, v91
    v_dot2_f32_bf16 v92, v17, s39, v92
    v_dot2_f32_bf16 v93, v17, v17, v93
    v_dot2_f32_bf16 v90, v18, s39, v90
    v_dot2_f32_bf16 v91, v18, v18, v91
    v_dot2_f32_bf16 v92, v19, s39, v92
    v_dot2_f32_bf16 v93, v19, v19, v93
    v_dot2_f32_bf16 v90, v20, s39, v90
    v_dot2_f32_bf16 v91, v20, v20, v91
    v_dot2_f32_bf16 v92, v21, s39, v92
    v_dot2_f32_bf16 v93, v21, v21, v93
    v_dot2_f32_bf16 v90, v22, s39, v90
    v_dot2_f32_bf16 v91, v22, v22, v91
    v_dot2_f32_bf16 v92, v23, s39, v92
    v_dot2_f32_bf16 v93, v23, v23, v93
    v_dot2_f32_bf16 v90, v24, s39, v90
    v_dot2_f32_bf16 v91, v24, v24, v91
    v_dot2_f32_bf16 v92, v25, s39, v92
    v_dot2_f32_bf16 v93, v25, v25, v93
    v_dot2_f32_bf16 v90, v26, s39, v90
    v_dot2_f32_bf16 v91, v26, v26, v91
    v_dot2_f32_bf16 v92, v27, s39, v92
    v_dot2_f32_bf16 v93, v27, v27, v93
    v_dot2_f32_bf16 v90, v28, s39, v90
    v_dot2_f32_bf16 v91, v28, v28, v91
    v_dot2_f32_bf16 v92, v29, s39, v92
    v_dot2_f32_bf16 v93, v29, v29, v93
    v_dot2_f32_bf16 v90, v30, s39, v90
    v_dot2_f32_bf16 v91, v30, v30, v91
    v_dot2_f32_bf16 v92, v31, s39, v92
    v_dot2_f32_bf16 v93, v31, v31, v93
    v_dot2_f32_bf16 v90, v32, s39, v90
    v_dot2_f32_bf16 v91, v32, v32, v91
    v_dot2_f32_bf16 v92, v33, s39, v92
    v_dot2_f32_bf16 v93, v33, v33, v93
    v_dot2_f32_bf16 v90, v34, s39, v90
    v_dot2_f32_bf16 v91, v34, v34, v91
    v_dot2_f32_bf16 v92, v35, s39, v92
    v_dot2_f32_bf16 v93, v35, v35, v93
    v_mov_b32 v94, 0
    v_mov_b32 v95, 0
    v_mov_b32 v96, 0
    v_mov_b32 v97, 0
    v_dot2_f32_bf16 v94, v36, s39, v94
    v_dot2_f32_bf16 v95, v36, v36, v95
    v_dot2_f32_bf16 v96, v37, s39, v96
    v_dot2_f32_bf16 v97, v37, v37, v97
    v_dot2_f32_bf16 v94, v38, s39, v94
    v_dot2_f32_bf16 v95, v38, v38, v95
    v_dot2_f32_bf16 v96, v39, s39, v96
    v_dot2_f32_bf16 v97, v39, v39, v97
    v_dot2_f32_bf16 v94, v40, s39, v94
    v_dot2_f32_bf16 v95, v40, v40, v95
    v_dot2_f32_bf16 v96, v41, s39, v96
    v_dot2_f32_bf16 v97, v41, v41, v97
    v_dot2_f32_bf16 v94, v42, s39, v94
    v_dot2_f32_bf16 v95, v42, v42, v95
    v_dot2_f32_bf16 v96, v43, s39, v96
    v_dot2_f32_bf16 v97, v43, v43, v97
    v_dot2_f32_bf16 v94, v44, s39, v94
    v_dot2_f32_bf16 v95, v44, v44, v95
    v_dot2_f32_bf16 v96, v45, s39, v96
    v_dot2_f32_bf16 v97, v45, v45, v97
    v_dot2_f32_bf16 v94, v46, s39, v94
    v_dot2_f32_bf16 v95, v46, v46, v95
    v_dot2_f32_bf16 v96, v47, s39, v96
    v_dot2_f32_bf16 v97, v47, v47, v97
    v_dot2_f32_bf16 v94, v48, s39, v94
    v_dot2_f32_bf16 v95, v48, v48, v95
    v_dot2_f32_bf16 v96, v49, s39, v96
    v_dot2_f32_bf16 v97, v49, v49, v97
    v_dot2_f32_bf16 v94, v50, s39, v94
    v_dot2_f32_bf16 v95, v50, v50, v95
    v_dot2_f32_bf16 v96, v51, s39, v96
    v_dot2_f32_bf16 v97, v51, v51, v97
    v_dot2_f32_bf16 v94, v52, s39, v94
    v_dot2_f32_bf16 v95, v52, v52, v95
    v_dot2_f32_bf16 v96, v53, s39, v96
    v_dot2_f32_bf16 v97, v53, v53, v97
    v_dot2_f32_bf16 v94, v54, s39, v94
    v_dot2_f32_bf16 v95, v54, v54, v95
    v_dot2_f32_bf16 v96, v55, s39, v96
    v_dot2_f32_bf16 v97, v55, v55, v97
    s_nop 3
    v_add_f32 v90, v90, v92
    v_add_f32 v91, v91, v93
    v_add_f32 v94, v94, v96
    v_add_f32 v95, v95, v97
    s_nop 1
    v_add_f32_dpp v90, v90, v90 row_ror:8 row_mask:0xf bank_mask:0xf
    v_add_f32_dpp v91, v91, v91 row_ror:8 row_mask:0xf bank_mask:0xf
    v_add_f32_dpp v94, v94, v94 row_ror:8 row_mask:0xf bank_mask:0xf
    v_add_f32_dpp v95, v95, v95 row_ror:8 row_mask:0xf bank_mask:0xf
    s_nop 1
    v_add_f32_dpp v90, v90, v90 row_ror:4 row_mask:0xf bank_mask:0xf
    v_add_f32_dpp v91, v91, v91 row_ror:4 row_mask:0xf bank_mask:0xf
    v_add_f32_dpp v94, v94, v94 row_ror:4 row_mask:0xf bank_mask:0xf
    v_add_f32_dpp v95, v95, v95 row_ror:4 row_mask:0xf bank_mask:0xf
    s_nop 1
    v_add_f32_dpp v90, v90, v90 row_ror:2 row_mask:0xf bank_mask:0xf
    v_add_f32_dpp v91, v91, v91 row_ror:2 row_mask:0xf bank_mask:0xf
    v_add_f32_dpp v94, v94, v94 row_ror:2 row_mask:0xf bank_mask:0xf
    v_add_f32_dpp v95, v95, v95 row_ror:2 row_mask:0xf bank_mask:0xf
    s_nop 1
    v_add_f32_dpp v90, v90, v90 row_ror:1 row_mask:0xf bank_mask:0xf
    v_add_f32_dpp v91, v91, v91 row_ror:1 row_mask:0xf bank_mask:0xf
    v_add_f32_dpp v94, v94, v94 row_ror:1 row_mask:0xf bank_mask:0xf
    v_add_f32_dpp v95, v95, v95 row_ror:1 row_mask:0xf bank_mask:0xf
    v_cmp_eq_u32 vcc, 1, v4
    s_nop 1
    v_cndmask_b32 v90, v90, v94, vcc
    v_cndmask_b32 v91, v91, v95, vcc
    s_mov_b32 s24, 0x3acccccd
    v_mul_f32 v90, s24, v90
    v_mul_f32 v91, s24, v91
    v_fma_f32 v91, -v90, v90, v91
    v_max_f32 v91, 0, v91
    v_cvt_pk_bf16_f32 v92, v90, v91
    v_and_b32 v93, 0xffff0000, v92
    v_add_f32 v93, 0x3727c5ac, v93
    v_cvt_pk_bf16_f32 v93, v93, v93
    v_and_b32 v93, 0xffff0000, v93
    v_sqrt_f32 v93, v93
    s_nop 0
    v_cvt_pk_bf16_f32 v93, v93, v93
    v_and_b32 v93, 0xffff0000, v93
    v_rcp_f32 v95, v93
    v_and_b32 v94, 0xffff, v92
    v_or_b32 v94, v94, v93
    v_lshl_add_u32 v96, v4, 2, v5
    v_lshlrev_b32 v96, 3, v96
    v_mov_b32 v97, 0x80000000
    v_cmp_gt_u32 vcc, 2, v4
    s_nop 1
    v_cndmask_b32 v96, v97, v96, vcc
    buffer_store_dwordx2 v[94:95], v96, s[12:15], 0 offen sc1
    s_waitcnt vmcnt(1)
    v_lshlrev_b32 v100, 16, v56
    v_and_b32 v101, 0xffff0000, v56
    v_lshlrev_b32 v102, 16, v57
    v_and_b32 v103, 0xffff0000, v57
    v_lshlrev_b32 v104, 16, v58
    v_and_b32 v105, 0xffff0000, v58
    v_lshlrev_b32 v106, 16, v59
    v_and_b32 v107, 0xffff0000, v59
    v_lshlrev_b32 v108, 16, v60
    v_and_b32 v109, 0xffff0000, v60
    v_add_f32 v100, v100, v108
    v_add_f32 v101, v101, v109
    v_lshlrev_b32 v108, 16, v61
    v_and_b32 v109, 0xffff0000, v61
    v_add_f32 v102, v102, v108
    v_add_f32 v103, v103, v109
    v_lshlrev_b32 v108, 16, v62
    v_and_b32 v109, 0xffff0000, v62
    v_add_f32 v104, v104, v108
    v_add_f32 v105, v105, v109
    v_lshlrev_b32 v108, 16, v63
    v_and_b32 v109, 0xffff0000, v63
    v_add_f32 v106, v106, v108
    v_add_f32 v107, v107, v109
    v_lshlrev_b32 v108, 16, v64
    v_and_b32 v109, 0xffff0000, v64
    v_add_f32 v100, v100, v108
    v_add_f32 v101, v101, v109
    v_lshlrev_b32 v108, 16, v65
    v_and_b32 v109, 0xffff0000, v65
    v_add_f32 v102, v102, v108
    v_add_f32 v103, v103, v109
    v_lshlrev_b32 v108, 16, v66
    v_and_b32 v109, 0xffff0000, v66
    v_add_f32 v104, v104, v108
    v_add_f32 v105, v105, v109
    v_lshlrev_b32 v108, 16, v67
    v_and_b32 v109, 0xffff0000, v67
    v_add_f32 v106, v106, v108
    v_add_f32 v107, v107, v109
    v_lshlrev_b32 v108, 16, v68
    v_and_b32 v109, 0xffff0000, v68
    v_add_f32 v100, v100, v108
    v_add_f32 v101, v101, v109
    v_lshlrev_b32 v108, 16, v69
    v_and_b32 v109, 0xffff0000, v69
    v_add_f32 v102, v102, v108
    v_add_f32 v103, v103, v109
    v_lshlrev_b32 v108, 16, v70
    v_and_b32 v109, 0xffff0000, v70
    v_add_f32 v104, v104, v108
    v_add_f32 v105, v105, v109
    v_lshlrev_b32 v108, 16, v71
    v_and_b32 v109, 0xffff0000, v71
    v_add_f32 v106, v106, v108
    v_add_f32 v107, v107, v109
    v_lshlrev_b32 v108, 16, v72
    v_and_b32 v109, 0xffff0000, v72
    v_add_f32 v100, v100, v108
    v_add_f32 v101, v101, v109
    v_lshlrev_b32 v108, 16, v73
    v_and_b32 v109, 0xffff0000, v73
    v_add_f32 v102, v102, v108
    v_add_f32 v103, v103, v109
    v_lshlrev_b32 v108, 16, v74
    v_and_b32 v109, 0xffff0000, v74
    v_add_f32 v104, v104, v108
    v_add_f32 v105, v105, v109
    v_lshlrev_b32 v108, 16, v75
    v_and_b32 v109, 0xffff0000, v75
    v_add_f32 v106, v106, v108
    v_add_f32 v107, v107, v109
    v_lshlrev_b32 v108, 16, v76
    v_and_b32 v109, 0xffff0000, v76
    v_add_f32 v100, v100, v108
    v_add_f32 v101, v101, v109
    v_lshlrev_b32 v108, 16, v77
    v_and_b32 v109, 0xffff0000, v77
    v_add_f32 v102, v102, v108
    v_add_f32 v103, v103, v109
    v_lshlrev_b32 v108, 16, v78
    v_and_b32 v109, 0xffff0000, v78
    v_add_f32 v104, v104, v108
    v_add_f32 v105, v105, v109
    v_lshlrev_b32 v108, 16, v79
    v_and_b32 v109, 0xffff0000, v79
    v_add_f32 v106, v106, v108
    v_add_f32 v107, v107, v109
    v_lshlrev_b32 v108, 16, v80
    v_and_b32 v109, 0xffff0000, v80
    v_add_f32 v100, v100, v108
    v_add_f32 v101, v101, v109
    v_lshlrev_b32 v108, 16, v81
    v_and_b32 v109, 0xffff0000, v81
    v_add_f32 v102, v102, v108
    v_add_f32 v103, v103, v109
    v_lshlrev_b32 v108, 16, v82
    v_and_b32 v109, 0xffff0000, v82
    v_add_f32 v104, v104, v108
    v_add_f32 v105, v105, v109
    v_lshlrev_b32 v108, 16, v83
    v_and_b32 v109, 0xffff0000, v83
    v_add_f32 v106, v106, v108
    v_add_f32 v107, v107, v109
    v_lshlrev_b32 v108, 16, v84
    v_and_b32 v109, 0xffff0000, v84
    v_add_f32 v100, v100, v108
    v_add_f32 v101, v101, v109
    v_lshlrev_b32 v108, 16, v85
    v_and_b32 v109, 0xffff0000, v85
    v_add_f32 v102, v102, v108
    v_add_f32 v103, v103, v109
    v_lshlrev_b32 v108, 16, v86
    v_and_b32 v109, 0xffff0000, v86
    v_add_f32 v104, v104, v108
    v_add_f32 v105, v105, v109
    v_lshlrev_b32 v108, 16, v87
    v_and_b32 v109, 0xffff0000, v87
    v_add_f32 v106, v106, v108
    v_add_f32 v107, v107, v109
    v_mov_b32 v110, v100
    v_mov_b32 v111, v101
    v_mov_b32 v112, v102
    v_mov_b32 v113, v103
    v_mov_b32 v114, v104
    v_mov_b32 v115, v105
    v_mov_b32 v116, v106
    v_mov_b32 v117, v107
    s_nop 1
    v_permlane32_swap_b32 v100, v110
    v_permlane32_swap_b32 v101, v111
    v_permlane32_swap_b32 v102, v112
    v_permlane32_swap_b32 v103, v113
    v_permlane32_swap_b32 v104, v114
    v_permlane32_swap_b32 v105, v115
    v_permlane32_swap_b32 v106, v116
    v_permlane32_swap_b32 v107, v117
    s_nop 1
    v_add_f32 v100, v100, v110
    v_add_f32 v101, v101, v111
    v_add_f32 v102, v102, v112
    v_add_f32 v103, v103, v113
    v_add_f32 v104, v104, v114
    v_add_f32 v105, v105, v115
    v_add_f32 v106, v106, v116
    v_add_f32 v107, v107, v117
    v_mov_b32 v110, v100
    v_mov_b32 v111, v101
    v_mov_b32 v112, v102
    v_mov_b32 v113, v103
    v_mov_b32 v114, v104
    v_mov_b32 v115, v105
    v_mov_b32 v116, v106
    v_mov_b32 v117, v107
    s_nop 1
    v_permlane16_swap_b32 v100, v110
    v_permlane16_swap_b32 v101, v111
    v_permlane16_swap_b32 v102, v112
    v_permlane16_swap_b32 v103, v113
    v_permlane16_swap_b32 v104, v114
    v_permlane16_swap_b32 v105, v115
    v_permlane16_swap_b32 v106, v116
    v_permlane16_swap_b32 v107, v117
    s_nop 1
    v_add_f32 v100, v100, v110
    v_add_f32 v101, v101, v111
    v_add_f32 v102, v102, v112
    v_add_f32 v103, v103, v113
    v_add_f32 v104, v104, v114
    v_add_f32 v105, v105, v115
    v_add_f32 v106, v106, v116
    v_add_f32 v107, v107, v117
    s_lshl_b32 s24, s29, 9
    v_lshlrev_b32 v118, 5, v4
    v_add_u32 v118, s24, v118
    s_mov_b64 exec, 0xffff
    ds_write_b128 v118, v[100:103] offset:0
    ds_write_b128 v118, v[104:107] offset:16
    s_mov_b64 exec, -1
    s_waitcnt lgkmcnt(0)
    v_mov_b32 v119, 156688
    v_mov_b32 v120, 1
    s_mov_b64 exec, 1
    ds_add_rtn_u32 v120, v119, v120
    s_mov_b64 exec, -1
    s_waitcnt lgkmcnt(0)
    v_readfirstlane_b32 s36, v120
    s_nop 3
    s_waitcnt vmcnt(0)
    v_mov_b32 v121, 156768
    v_mov_b32 v122, 1
    s_mov_b64 exec, 1
    ds_add_rtn_u32 v122, v121, v122
    s_mov_b64 exec, -1
    s_waitcnt lgkmcnt(0)
    v_readfirstlane_b32 s24, v122
    s_nop 3
    s_cmp_lg_u32 s24, 3
    s_cbranch_scc1 nsd_20
    v_and_b32 v121, 63, v0
    s_lshr_b32 s24, s31, 2
    v_mov_b32 v122, s24
    v_lshrrev_b32 v123, 2, v122
    v_lshlrev_b32 v123, 1, v123
    v_cmp_le_u32 vcc, 6, v121
    s_nop 1
    v_cndmask_b32 v120, 0, 1, vcc
    v_add_u32 v123, v123, v120
    v_mul_u32_u24 v120, 6, v120
    v_sub_u32 v120, v121, v120
    v_lshlrev_b32 v120, 5, v120
    v_add_u32 v123, v123, v120
    v_and_b32 v120, 3, v122
    v_lshl_add_u32 v123, v120, 3, v123
    v_lshlrev_b32 v123, 9, v123
    s_and_b32 s24, s31, 3
    s_lshl_b32 s24, s24, 2
    s_add_u32 s24, s24, 195008
    v_add_u32 v123, s24, v123
    v_mov_b32 v120, s28
    s_mov_b64 s[48:49], exec
    s_mov_b64 exec, 0xfff
    buffer_store_dword v120, v123, s[40:43], 0 offen sc1
    s_mov_b64 exec, s[48:49]
nsd_20:
    s_cmp_lg_u32 s36, 3
    s_cbranch_scc1 nolast_21
    s_cmp_ge_u32 s21, 30
    s_cbranch_scc1 nolast_21
    v_lshlrev_b32 v121, 4, v2
    ds_read_b128 v[124:127], v121 offset:0
    ds_read_b128 v[128:131], v121 offset:512
    ds_read_b128 v[132:135], v121 offset:1024
    ds_read_b128 v[136:139], v121 offset:1536
    v_mov_b32 v97, 0x80000000
    v_cmp_gt_u32 vcc, 32, v2
    s_waitcnt lgkmcnt(0)
    v_add_f32 v124, v124, v128
    v_add_f32 v125, v125, v129
    v_add_f32 v126, v126, v130
    v_add_f32 v127, v127, v131
    v_add_f32 v124, v124, v132
    v_add_f32 v125, v125, v133
    v_add_f32 v126, v126, v134
    v_add_f32 v127, v127, v135
    v_add_f32 v124, v124, v136
    v_add_f32 v125, v125, v137
    v_add_f32 v126, v126, v138
    v_add_f32 v127, v127, v139
    v_cndmask_b32 v121, v97, v121, vcc
    s_mul_i32 s24, s32, 10
    s_add_u32 s24, s24, s33
    s_lshl_b32 s25, s24, 9
    buffer_store_dwordx4 v[124:127], v121, s[16:19], s25 offen sc1
    s_waitcnt vmcnt(0)
    v_and_b32 v121, 63, v0
    v_mov_b32 v122, s32
    v_lshrrev_b32 v123, 2, v121
    v_lshlrev_b32 v123, 1, v123
    v_cmp_le_u32 vcc, 6, v122
    s_nop 1
    v_cndmask_b32 v120, 0, 1, vcc
    v_add_u32 v123, v123, v120
    v_mul_u32_u24 v120, 6, v120
    v_sub_u32 v120, v122, v120
    v_lshlrev_b32 v120, 5, v120
    v_add_u32 v123, v123, v120
    v_and_b32 v120, 3, v121
    v_lshl_add_u32 v123, v120, 3, v123
    v_lshlrev_b32 v123, 9, v123
    s_lshl_b32 s24, s33, 2
    s_add_u32 s24, s24, 195024
    v_add_u32 v123, s24, v123
    v_mov_b32 v120, s28
    s_mov_b64 s[48:49], exec
    s_mov_b64 exec, 0xffff
    buffer_store_dword v120, v123, s[40:43], 0 offen sc1
    s_mov_b64 exec, s[48:49]
nolast_21:
    s_mov_b32 s38, 0
    s_branch L_htask
L_hpre:
    s_barrier
    s_mov_b32 s38, 0
    s_waitcnt lgkmcnt(0)
    s_add_u32 s50, s98, 13615104
    s_addc_u32 s51, s99, 0
    s_mov_b32 s48, 325632
    s_load_dword s28, s[50:51], s48
    s_mov_b64 s[40:41], s[98:99]
    s_add_u32 s40, s40, 13615104
    s_addc_u32 s41, s41, 0
    s_and_b32 s41, s41, 0xffff
    s_mov_b32 s42, 325760
    s_mov_b32 s43, 0x00020000
    s_mov_b64 s[44:45], s[96:97]
    s_and_b32 s45, s45, 0xffff
    s_mov_b32 s46, 256
    s_mov_b32 s47, 0x00020000
    s_waitcnt lgkmcnt(0)
    s_add_u32 s28, s28, 1
    s_branch L_htask
L_hiss:
    v_lshrrev_b32 v9, 3, v2
    s_movk_i32 s25, 1280
    v_mul_lo_u32 v9, v9, s25
    v_and_b32 v10, 7, v2
    v_xor_b32 v16, 0, v10
    v_lshl_add_u32 v16, v16, 4, v9
    v_xor_b32 v17, 1, v10
    v_lshl_add_u32 v17, v17, 4, v9
    v_xor_b32 v18, 2, v10
    v_lshl_add_u32 v18, v18, 4, v9
    v_xor_b32 v19, 3, v10
    v_lshl_add_u32 v19, v19, 4, v9
    v_xor_b32 v20, 4, v10
    v_lshl_add_u32 v20, v20, 4, v9
    v_xor_b32 v21, 5, v10
    v_lshl_add_u32 v21, v21, 4, v9
    v_xor_b32 v22, 6, v10
    v_lshl_add_u32 v22, v22, 4, v9
    v_xor_b32 v23, 7, v10
    v_lshl_add_u32 v23, v23, 4, v9
    v_mov_b32 v24, 0x80000000
    s_setprio 3
    s_waitcnt lgkmcnt(0)
    s_mov_b64 s[4:5], s[74:75]
    s_and_b32 s5, s5, 0xffff
    s_mov_b32 s6, 2621440
    s_mov_b32 s7, 0x00020000
    s_mov_b64 s[8:9], s[76:77]
    s_and_b32 s9, s9, 0xffff
    s_mov_b32 s10, 2621440
    s_mov_b32 s11, 0x00020000
    s_mov_b64 s[20:21], s[78:79]
    s_and_b32 s21, s21, 0xffff
    s_mov_b32 s22, 5120
    s_mov_b32 s23, 0x00020000
    s_barrier
    v_lshlrev_b32 v13, 4, v2
    s_movk_i32 s24, 0
    s_mov_b32 m0, 4096
    s_nop 0
    buffer_load_dwordx4 v13, s[20:23], s24 offen lds
    s_movk_i32 s24, 1024
    s_mov_b32 m0, 5120
    s_nop 0
    buffer_load_dwordx4 v13, s[20:23], s24 offen lds
    s_movk_i32 s24, 2048
    s_mov_b32 m0, 6144
    s_nop 0
    buffer_load_dwordx4 v13, s[20:23], s24 offen lds
    s_movk_i32 s24, 3072
    s_mov_b32 m0, 7168
    s_nop 0
    buffer_load_dwordx4 v13, s[20:23], s24 offen lds
    s_movk_i32 s24, 4096
    s_mov_b32 m0, 8192
    s_nop 0
    buffer_load_dwordx4 v13, s[20:23], s24 offen lds
    s_mul_i32 s24, s30, 5
    s_add_u32 s24, s24, 0
    s_lshr_b32 s25, s24, 5
    s_and_b32 s34, s24, 31
    s_mul_i32 s24, s34, 81920
    s_lshl_b32 s25, s25, 7
    s_add_u32 s24, s24, s25
    s_mov_b32 m0, 10240
    s_cmp_eq_u32 s34, 0
    s_cbranch_scc1 kz_22
    s_sub_u32 s25, s24, 10240
    buffer_load_dwordx4 v16, s[4:7], s25 offen nt lds
    s_branch kz2_23
kz_22:
    buffer_load_dwordx4 v24, s[4:7], 0 offen nt lds
kz2_23:
    s_mov_b32 m0, 11264
    s_add_u32 s25, s24, 0
    buffer_load_dwordx4 v17, s[4:7], s25 offen nt lds
    s_mov_b32 m0, 12288
    s_add_u32 s25, s24, 10240
    buffer_load_dwordx4 v18, s[4:7], s25 offen nt lds
    s_mov_b32 m0, 13312
    s_add_u32 s25, s24, 20480
    buffer_load_dwordx4 v19, s[4:7], s25 offen nt lds
    s_mov_b32 m0, 14336
    s_add_u32 s25, s24, 30720
    buffer_load_dwordx4 v20, s[4:7], s25 offen nt lds
    s_mov_b32 m0, 15360
    s_add_u32 s25, s24, 40960
    buffer_load_dwordx4 v21, s[4:7], s25 offen nt lds
    s_mov_b32 m0, 16384
    s_add_u32 s25, s24, 51200
    buffer_load_dwordx4 v22, s[4:7], s25 offen nt lds
    s_mov_b32 m0, 17408
    s_add_u32 s25, s24, 61440
    buffer_load_dwordx4 v23, s[4:7], s25 offen nt lds
    s_mov_b32 m0, 18432
    s_add_u32 s25, s24, 71680
    buffer_load_dwordx4 v16, s[4:7], s25 offen nt lds
    s_mov_b32 m0, 19456
    s_add_u32 s25, s24, 0
    buffer_load_dwordx4 v17, s[8:11], s25 offen nt lds
    s_mov_b32 m0, 20480
    s_add_u32 s25, s24, 10240
    buffer_load_dwordx4 v18, s[8:11], s25 offen nt lds
    s_mov_b32 m0, 21504
    s_add_u32 s25, s24, 20480
    buffer_load_dwordx4 v19, s[8:11], s25 offen nt lds
    s_mov_b32 m0, 22528
    s_add_u32 s25, s24, 30720
    buffer_load_dwordx4 v20, s[8:11], s25 offen nt lds
    s_mov_b32 m0, 23552
    s_add_u32 s25, s24, 40960
    buffer_load_dwordx4 v21, s[8:11], s25 offen nt lds
    s_mov_b32 m0, 24576
    s_add_u32 s25, s24, 51200
    buffer_load_dwordx4 v22, s[8:11], s25 offen nt lds
    s_mov_b32 m0, 25600
    s_add_u32 s25, s24, 61440
    buffer_load_dwordx4 v23, s[8:11], s25 offen nt lds
    s_mov_b32 m0, 26624
    s_add_u32 s25, s24, 71680
    buffer_load_dwordx4 v16, s[8:11], s25 offen nt lds
    s_mul_i32 s24, s30, 5
    s_add_u32 s24, s24, 1
    s_lshr_b32 s25, s24, 5
    s_and_b32 s34, s24, 31
    s_mul_i32 s24, s34, 81920
    s_lshl_b32 s25, s25, 7
    s_add_u32 s24, s24, s25
    s_mov_b32 m0, 27648
    s_cmp_eq_u32 s34, 0
    s_cbranch_scc1 kz_24
    s_sub_u32 s25, s24, 10240
    buffer_load_dwordx4 v16, s[4:7], s25 offen nt lds
    s_branch kz2_25
kz_24:
    buffer_load_dwordx4 v24, s[4:7], 0 offen nt lds
kz2_25:
    s_mov_b32 m0, 28672
    s_add_u32 s25, s24, 0
    buffer_load_dwordx4 v17, s[4:7], s25 offen nt lds
    s_mov_b32 m0, 29696
    s_add_u32 s25, s24, 10240
    buffer_load_dwordx4 v18, s[4:7], s25 offen nt lds
    s_mov_b32 m0, 30720
    s_add_u32 s25, s24, 20480
    buffer_load_dwordx4 v19, s[4:7], s25 offen nt lds
    s_mov_b32 m0, 31744
    s_add_u32 s25, s24, 30720
    buffer_load_dwordx4 v20, s[4:7], s25 offen nt lds
    s_mov_b32 m0, 32768
    s_add_u32 s25, s24, 40960
    buffer_load_dwordx4 v21, s[4:7], s25 offen nt lds
    s_mov_b32 m0, 33792
    s_add_u32 s25, s24, 51200
    buffer_load_dwordx4 v22, s[4:7], s25 offen nt lds
    s_mov_b32 m0, 34816
    s_add_u32 s25, s24, 61440
    buffer_load_dwordx4 v23, s[4:7], s25 offen nt lds
    s_mov_b32 m0, 35840
    s_add_u32 s25, s24, 71680
    buffer_load_dwordx4 v16, s[4:7], s25 offen nt lds
    s_mov_b32 m0, 36864
    s_add_u32 s25, s24, 0
    buffer_load_dwordx4 v17, s[8:11], s25 offen nt lds
    s_mov_b32 m0, 37888
    s_add_u32 s25, s24, 10240
    buffer_load_dwordx4 v18, s[8:11], s25 offen nt lds
    s_mov_b32 m0, 38912
    s_add_u32 s25, s24, 20480
    buffer_load_dwordx4 v19, s[8:11], s25 offen nt lds
    s_mov_b32 m0, 39936
    s_add_u32 s25, s24, 30720
    buffer_load_dwordx4 v20, s[8:11], s25 offen nt lds
    s_mov_b32 m0, 40960
    s_add_u32 s25, s24, 40960
    buffer_load_dwordx4 v21, s[8:11], s25 offen nt lds
    s_mov_b32 m0, 41984
    s_add_u32 s25, s24, 51200
    buffer_load_dwordx4 v22, s[8:11], s25 offen nt lds
    s_mov_b32 m0, 43008
    s_add_u32 s25, s24, 61440
    buffer_load_dwordx4 v23, s[8:11], s25 offen nt lds
    s_mov_b32 m0, 44032
    s_add_u32 s25, s24, 71680
    buffer_load_dwordx4 v16, s[8:11], s25 offen nt lds
    s_waitcnt lgkmcnt(0)
    s_add_u32 s50, s98, 13615104
    s_addc_u32 s51, s99, 0
    s_mov_b32 s48, 325632
    s_load_dword s28, s[50:51], s48
    s_mov_b64 s[40:41], s[98:99]
    s_add_u32 s40, s40, 13615104
    s_addc_u32 s41, s41, 0
    s_and_b32 s41, s41, 0xffff
    s_mov_b32 s42, 325760
    s_mov_b32 s43, 0x00020000
    s_mov_b64 s[44:45], s[96:97]
    s_and_b32 s45, s45, 0xffff
    s_mov_b32 s46, 256
    s_mov_b32 s47, 0x00020000
    s_waitcnt lgkmcnt(0)
    s_add_u32 s28, s28, 1
    s_waitcnt vmcnt(17)
    v_mov_b32 v40, 156708
    v_mov_b32 v41, 1
    s_mov_b64 s[48:49], exec
    s_mov_b64 exec, 1
    ds_write_b32 v40, v41
    s_mov_b64 exec, s[48:49]
    s_waitcnt vmcnt(0)
    v_mov_b32 v40, 156712
    v_mov_b32 v41, 1
    s_mov_b64 s[48:49], exec
    s_mov_b64 exec, 1
    ds_write_b32 v40, v41
    s_mov_b64 exec, s[48:49]
    s_mov_b32 s26, 0
    v_mov_b32 v40, 156692
ldsw_26:
    ds_read_b32 v41, v40
    s_waitcnt lgkmcnt(0)
    v_readfirstlane_b32 s24, v41
    s_nop 3
    s_cmp_lg_u32 s24, 0
    s_cbranch_scc1 ldswd_27
    s_sleep 2
    s_add_u32 s26, s26, 1
    s_cmp_lt_u32 s26, 800000
    s_cbranch_scc1 ldsw_26
    v_mov_b32 v250, 4
    v_mov_b32 v251, 0xdead
    buffer_store_dword v251, v250, s[44:47], 0 offen sc1
ldswd_27:
    s_mul_i32 s24, s30, 5
    s_add_u32 s24, s24, 2
    s_lshr_b32 s25, s24, 5
    s_and_b32 s34, s24, 31
    s_mul_i32 s24, s34, 81920
    s_lshl_b32 s25, s25, 7
    s_add_u32 s24, s24, s25
    s_mov_b32 m0, 45056
    s_cmp_eq_u32 s34, 0
    s_cbranch_scc1 kz_28
    s_sub_u32 s25, s24, 10240
    buffer_load_dwordx4 v16, s[4:7], s25 offen nt lds
    s_branch kz2_29
kz_28:
    buffer_load_dwordx4 v24, s[4:7], 0 offen nt lds
kz2_29:
    s_mov_b32 m0, 46080
    s_add_u32 s25, s24, 0
    buffer_load_dwordx4 v17, s[4:7], s25 offen nt lds
    s_mov_b32 m0, 47104
    s_add_u32 s25, s24, 10240
    buffer_load_dwordx4 v18, s[4:7], s25 offen nt lds
    s_mov_b32 m0, 48128
    s_add_u32 s25, s24, 20480
    buffer_load_dwordx4 v19, s[4:7], s25 offen nt lds
    s_mov_b32 m0, 49152
    s_add_u32 s25, s24, 30720
    buffer_load_dwordx4 v20, s[4:7], s25 offen nt lds
    s_mov_b32 m0, 50176
    s_add_u32 s25, s24, 40960
    buffer_load_dwordx4 v21, s[4:7], s25 offen nt lds
    s_mov_b32 m0, 51200
    s_add_u32 s25, s24, 51200
    buffer_load_dwordx4 v22, s[4:7], s25 offen nt lds
    s_mov_b32 m0, 52224
    s_add_u32 s25, s24, 61440
    buffer_load_dwordx4 v23, s[4:7], s25 offen nt lds
    s_mov_b32 m0, 53248
    s_add_u32 s25, s24, 71680
    buffer_load_dwordx4 v16, s[4:7], s25 offen nt lds
    s_mov_b32 m0, 54272
    s_add_u32 s25, s24, 0
    buffer_load_dwordx4 v17, s[8:11], s25 offen nt lds
    s_mov_b32 m0, 55296
    s_add_u32 s25, s24, 10240
    buffer_load_dwordx4 v18, s[8:11], s25 offen nt lds
    s_mov_b32 m0, 56320
    s_add_u32 s25, s24, 20480
    buffer_load_dwordx4 v19, s[8:11], s25 offen nt lds
    s_mov_b32 m0, 57344
    s_add_u32 s25, s24, 30720
    buffer_load_dwordx4 v20, s[8:11], s25 offen nt lds
    s_mov_b32 m0, 58368
    s_add_u32 s25, s24, 40960
    buffer_load_dwordx4 v21, s[8:11], s25 offen nt lds
    s_mov_b32 m0, 59392
    s_add_u32 s25, s24, 51200
    buffer_load_dwordx4 v22, s[8:11], s25 offen nt lds
    s_mov_b32 m0, 60416
    s_add_u32 s25, s24, 61440
    buffer_load_dwordx4 v23, s[8:11], s25 offen nt lds
    s_mov_b32 m0, 61440
    s_add_u32 s25, s24, 71680
    buffer_load_dwordx4 v16, s[8:11], s25 offen nt lds
    s_mul_i32 s24, s30, 5
    s_add_u32 s24, s24, 3
    s_lshr_b32 s25, s24, 5
    s_and_b32 s34, s24, 31
    s_mul_i32 s24, s34, 81920
    s_lshl_b32 s25, s25, 7
    s_add_u32 s24, s24, s25
    s_mov_b32 m0, 62464
    s_cmp_eq_u32 s34, 0
    s_cbranch_scc1 kz_30
    s_sub_u32 s25, s24, 10240
    buffer_load_dwordx4 v16, s[4:7], s25 offen nt lds
    s_branch kz2_31
kz_30:
    buffer_load_dwordx4 v24, s[4:7], 0 offen nt lds
kz2_31:
    s_mov_b32 m0, 63488
    s_add_u32 s25, s24, 0
    buffer_load_dwordx4 v17, s[4:7], s25 offen nt lds
    s_mov_b32 m0, 64512
    s_add_u32 s25, s24, 10240
    buffer_load_dwordx4 v18, s[4:7], s25 offen nt lds
    s_mov_b32 m0, 65536
    s_add_u32 s25, s24, 20480
    buffer_load_dwordx4 v19, s[4:7], s25 offen nt lds
    s_mov_b32 m0, 66560
    s_add_u32 s25, s24, 30720
    buffer_load_dwordx4 v20, s[4:7], s25 offen nt lds
    s_mov_b32 m0, 67584
    s_add_u32 s25, s24, 40960
    buffer_load_dwordx4 v21, s[4:7], s25 offen nt lds
    s_mov_b32 m0, 68608
    s_add_u32 s25, s24, 51200
    buffer_load_dwordx4 v22, s[4:7], s25 offen nt lds
    s_mov_b32 m0, 69632
    s_add_u32 s25, s24, 61440
    buffer_load_dwordx4 v23, s[4:7], s25 offen nt lds
    s_mov_b32 m0, 70656
    s_add_u32 s25, s24, 71680
    buffer_load_dwordx4 v16, s[4:7], s25 offen nt lds
    s_mov_b32 m0, 71680
    s_add_u32 s25, s24, 0
    buffer_load_dwordx4 v17, s[8:11], s25 offen nt lds
    s_mov_b32 m0, 72704
    s_add_u32 s25, s24, 10240
    buffer_load_dwordx4 v18, s[8:11], s25 offen nt lds
    s_mov_b32 m0, 73728
    s_add_u32 s25, s24, 20480
    buffer_load_dwordx4 v19, s[8:11], s25 offen nt lds
    s_mov_b32 m0, 74752
    s_add_u32 s25, s24, 30720
    buffer_load_dwordx4 v20, s[8:11], s25 offen nt lds
    s_mov_b32 m0, 75776
    s_add_u32 s25, s24, 40960
    buffer_load_dwordx4 v21, s[8:11], s25 offen nt lds
    s_mov_b32 m0, 76800
    s_add_u32 s25, s24, 51200
    buffer_load_dwordx4 v22, s[8:11], s25 offen nt lds
    s_mov_b32 m0, 77824
    s_add_u32 s25, s24, 61440
    buffer_load_dwordx4 v23, s[8:11], s25 offen nt lds
    s_mov_b32 m0, 78848
    s_add_u32 s25, s24, 71680
    buffer_load_dwordx4 v16, s[8:11], s25 offen nt lds
    s_waitcnt vmcnt(17)
    v_mov_b32 v40, 156716
    v_mov_b32 v41, 1
    s_mov_b64 s[48:49], exec
    s_mov_b64 exec, 1
    ds_write_b32 v40, v41
    s_mov_b64 exec, s[48:49]
    s_mul_i32 s24, s30, 5
    s_add_u32 s24, s24, 4
    s_lshr_b32 s25, s24, 5
    s_and_b32 s34, s24, 31
    s_mul_i32 s24, s34, 81920
    s_lshl_b32 s25, s25, 7
    s_add_u32 s24, s24, s25
    s_mov_b32 m0, 79872
    s_cmp_eq_u32 s34, 0
    s_cbranch_scc1 kz_32
    s_sub_u32 s25, s24, 10240
    buffer_load_dwordx4 v16, s[4:7], s25 offen nt lds
    s_branch kz2_33
kz_32:
    buffer_load_dwordx4 v24, s[4:7], 0 offen nt lds
kz2_33:
    s_mov_b32 m0, 80896
    s_add_u32 s25, s24, 0
    buffer_load_dwordx4 v17, s[4:7], s25 offen nt lds
    s_mov_b32 m0, 81920
    s_add_u32 s25, s24, 10240
    buffer_load_dwordx4 v18, s[4:7], s25 offen nt lds
    s_mov_b32 m0, 82944
    s_add_u32 s25, s24, 20480
    buffer_load_dwordx4 v19, s[4:7], s25 offen nt lds
    s_mov_b32 m0, 83968
    s_add_u32 s25, s24, 30720
    buffer_load_dwordx4 v20, s[4:7], s25 offen nt lds
    s_mov_b32 m0, 84992
    s_add_u32 s25, s24, 40960
    buffer_load_dwordx4 v21, s[4:7], s25 offen nt lds
    s_mov_b32 m0, 86016
    s_add_u32 s25, s24, 51200
    buffer_load_dwordx4 v22, s[4:7], s25 offen nt lds
    s_mov_b32 m0, 87040
    s_add_u32 s25, s24, 61440
    buffer_load_dwordx4 v23, s[4:7], s25 offen nt lds
    s_mov_b32 m0, 88064
    s_add_u32 s25, s24, 71680
    buffer_load_dwordx4 v16, s[4:7], s25 offen nt lds
    s_mov_b32 m0, 89088
    s_add_u32 s25, s24, 0
    buffer_load_dwordx4 v17, s[8:11], s25 offen nt lds
    s_mov_b32 m0, 90112
    s_add_u32 s25, s24, 10240
    buffer_load_dwordx4 v18, s[8:11], s25 offen nt lds
    s_mov_b32 m0, 91136
    s_add_u32 s25, s24, 20480
    buffer_load_dwordx4 v19, s[8:11], s25 offen nt lds
    s_mov_b32 m0, 92160
    s_add_u32 s25, s24, 30720
    buffer_load_dwordx4 v20, s[8:11], s25 offen nt lds
    s_mov_b32 m0, 93184
    s_add_u32 s25, s24, 40960
    buffer_load_dwordx4 v21, s[8:11], s25 offen nt lds
    s_mov_b32 m0, 94208
    s_add_u32 s25, s24, 51200
    buffer_load_dwordx4 v22, s[8:11], s25 offen nt lds
    s_mov_b32 m0, 95232
    s_add_u32 s25, s24, 61440
    buffer_load_dwordx4 v23, s[8:11], s25 offen nt lds
    s_mov_b32 m0, 96256
    s_add_u32 s25, s24, 71680
    buffer_load_dwordx4 v16, s[8:11], s25 offen nt lds
    s_waitcnt vmcnt(17)
    v_mov_b32 v40, 156720
    v_mov_b32 v41, 1
    s_mov_b64 s[48:49], exec
    s_mov_b64 exec, 1
    ds_write_b32 v40, v41
    s_mov_b64 exec, s[48:49]
    s_waitcnt vmcnt(0)
    v_mov_b32 v40, 156724
    v_mov_b32 v41, 1
    s_mov_b64 s[48:49], exec
    s_mov_b64 exec, 1
    ds_write_b32 v40, v41
    s_mov_b64 exec, s[48:49]
    s_setprio 0
    s_branch L_hend
L_htask:
    v_and_b32 v3, 7, v2
    v_lshrrev_b32 v4, 3, v2
    v_add_u32 v5, 1, v3
    v_and_b32 v6, 7, v5
    v_and_b32 v7, 3, v4
    v_lshlrev_b32 v7, 2, v7
    v_lshrrev_b32 v8, 2, v4
    v_lshlrev_b32 v9, 10, v3
    v_lshlrev_b32 v10, 13, v4
    v_sub_u32 v11, 7, v3
    v_lshl_add_u32 v10, v11, 4, v10
    v_lshlrev_b32 v11, 4, v4
    s_waitcnt lgkmcnt(0)
    s_mov_b64 s[52:53], s[98:99]
    s_add_u32 s52, s52, 8257536
    s_addc_u32 s53, s53, 0
    s_and_b32 s53, s53, 0xffff
    s_mov_b32 s54, 2621440
    s_mov_b32 s55, 0x00020000
tl_34:
    v_mov_b32 v12, 156696
    v_mov_b32 v13, 1
    s_mov_b64 exec, 1
    ds_add_rtn_u32 v13, v12, v13
    s_mov_b64 exec, -1
    s_waitcnt lgkmcnt(0)
    v_readfirstlane_b32 s34, v13
    s_nop 3
    s_cmp_ge_u32 s34, 20
    s_cbranch_scc1 td_35
    s_lshr_b32 s35, s34, 2
    s_and_b32 s34, s34, 3
    s_lshl_b32 s24, s35, 2
    s_add_u32 s27, s24, 156708
    s_lshl_b32 s24, s34, 1
    v_add_u32 v12, s24, v8
    v_xor_b32 v13, v12, v3
    v_lshl_add_u32 v13, v13, 4, v7
    v_add_u32 v13, v13, v9
    v_xor_b32 v14, v12, v6
    v_lshl_add_u32 v14, v14, 4, v7
    v_add_u32 v15, v14, v9
    s_mul_i32 s24, s35, 17408
    s_add_u32 s24, s24, 10240
    v_add_u32 v13, s24, v13
    v_add_u32 v15, s24, v15
    s_mul_i32 s24, s30, 5
    s_add_u32 s24, s24, s35
    s_lshr_b32 s21, s24, 5
    s_and_b32 s20, s24, 31
    s_lshl_b32 s24, s21, 9
    s_lshl_b32 s25, s34, 7
    s_add_u32 s24, s24, s25
    s_add_u32 s24, s24, 4096
    v_add_u32 v12, s24, v11
    v_mov_b32 v16, s27
    s_mov_b32 s26, 0
tw_36:
    ds_read_b32 v17, v16
    s_waitcnt lgkmcnt(0)
    v_readfirstlane_b32 s24, v17
    s_nop 3
    s_cmp_lg_u32 s24, 0
    s_cbranch_scc1 twd_37
    s_sleep 1
    s_add_u32 s26, s26, 1
    s_cmp_lt_u32 s26, 800000
    s_cbranch_scc1 tw_36
    v_mov_b32 v250, 4
    v_mov_b32 v251, 0xdead
    buffer_store_dword v251, v250, s[44:47], 0 offen sc1
twd_37:
    ds_read_b128 v[16:19], v12
    ds_read_b32 v20, v13 offset:640
    ds_read_b32 v21, v13 offset:768
    ds_read_b32 v22, v13 offset:896
    ds_read_b32 v23, v15 offset:1024
    ds_read_b32 v24, v15 offset:1152
    ds_read_b32 v25, v15 offset:1280
    ds_read_b32 v26, v15 offset:1408
    ds_read_b32 v27, v15 offset:1536
    ds_read_b32 v28, v15 offset:1664
    ds_read_b32 v29, v15 offset:1792
    ds_read_b32 v30, v15 offset:1920
    ds_read_b32 v32, v15 offset:9216
    ds_read_b32 v33, v15 offset:9344
    ds_read_b32 v34, v15 offset:9472
    ds_read_b32 v35, v15 offset:9600
    ds_read_b32 v36, v15 offset:9728
    ds_read_b32 v37, v15 offset:9856
    ds_read_b32 v38, v15 offset:9984
    ds_read_b32 v39, v15 offset:10112
    s_lshl_b32 s25, s20, 6
    s_sub_u32 s24, 1984, s25
    s_lshl_b32 s24, s24, 1
    s_lshl_b32 s25, s21, 18
    s_add_u32 s24, s24, s25
    s_lshl_b32 s25, s34, 16
    s_add_u32 s22, s24, s25
    s_add_u32 s23, s22, 4096
    s_waitcnt lgkmcnt(8)
    v_lshlrev_b32 v40, 16, v16
    v_lshlrev_b32 v41, 16, v18
    v_and_b32 v42, 0xffff0000, v16
    v_and_b32 v43, 0xffff0000, v18
    v_lshlrev_b32 v44, 16, v17
    v_lshlrev_b32 v45, 16, v19
    v_and_b32 v46, 0xffff0000, v17
    v_and_b32 v47, 0xffff0000, v19
    v_lshlrev_b32 v48, 16, v20
    v_and_b32 v49, 0xffff0000, v20
    v_lshlrev_b32 v50, 16, v21
    v_and_b32 v51, 0xffff0000, v21
    v_lshlrev_b32 v52, 16, v22
    v_and_b32 v53, 0xffff0000, v22
    v_lshlrev_b32 v54, 16, v23
    v_and_b32 v55, 0xffff0000, v23
    v_lshlrev_b32 v56, 16, v24
    v_and_b32 v57, 0xffff0000, v24
    v_lshlrev_b32 v58, 16, v25
    v_and_b32 v59, 0xffff0000, v25
    v_lshlrev_b32 v60, 16, v26
    v_and_b32 v61, 0xffff0000, v26
    v_lshlrev_b32 v62, 16, v27
    v_and_b32 v63, 0xffff0000, v27
    v_lshlrev_b32 v64, 16, v28
    v_and_b32 v65, 0xffff0000, v28
    v_lshlrev_b32 v66, 16, v29
    v_and_b32 v67, 0xffff0000, v29
    v_lshlrev_b32 v68, 16, v30
    v_and_b32 v69, 0xffff0000, v30
    s_waitcnt lgkmcnt(0)
    v_lshlrev_b32 v72, 16, v32
    v_and_b32 v73, 0xffff0000, v32
    v_lshlrev_b32 v74, 16, v33
    v_and_b32 v75, 0xffff0000, v33
    v_lshlrev_b32 v76, 16, v34
    v_and_b32 v77, 0xffff0000, v34
    v_lshlrev_b32 v78, 16, v35
    v_and_b32 v79, 0xffff0000, v35
    v_lshlrev_b32 v80, 16, v36
    v_and_b32 v81, 0xffff0000, v36
    v_lshlrev_b32 v82, 16, v37
    v_and_b32 v83, 0xffff0000, v37
    v_lshlrev_b32 v84, 16, v38
    v_and_b32 v85, 0xffff0000, v38
    v_lshlrev_b32 v86, 16, v39
    v_and_b32 v87, 0xffff0000, v39
    v_pk_mul_f32 v[96:97], v[48:49], v[46:47]
    v_pk_mul_f32 v[100:101], v[50:51], v[46:47]
    v_pk_mul_f32 v[104:105], v[52:53], v[46:47]
    v_pk_mul_f32 v[108:109], v[54:55], v[46:47]
    v_cvt_pk_bf16_f32 v96, 0, v96
    v_cvt_pk_bf16_f32 v97, 0, v97
    v_cvt_pk_bf16_f32 v100, 0, v100
    v_cvt_pk_bf16_f32 v101, 0, v101
    v_cvt_pk_bf16_f32 v104, 0, v104
    v_cvt_pk_bf16_f32 v105, 0, v105
    v_cvt_pk_bf16_f32 v108, 0, v108
    v_cvt_pk_bf16_f32 v109, 0, v109
    v_pk_mul_f32 v[98:99], v[50:51], v[44:45]
    v_pk_mul_f32 v[102:103], v[52:53], v[44:45]
    v_pk_mul_f32 v[106:107], v[54:55], v[44:45]
    v_pk_mul_f32 v[110:111], v[56:57], v[44:45]
    v_cvt_pk_bf16_f32 v98, 0, v98
    v_cvt_pk_bf16_f32 v99, 0, v99
    v_cvt_pk_bf16_f32 v102, 0, v102
    v_cvt_pk_bf16_f32 v103, 0, v103
    v_cvt_pk_bf16_f32 v106, 0, v106
    v_cvt_pk_bf16_f32 v107, 0, v107
    v_cvt_pk_bf16_f32 v110, 0, v110
    v_cvt_pk_bf16_f32 v111, 0, v111
    v_pk_add_f32 v[96:97], v[96:97], v[98:99]
    v_pk_add_f32 v[100:101], v[100:101], v[102:103]
    v_pk_add_f32 v[104:105], v[104:105], v[106:107]
    v_pk_add_f32 v[108:109], v[108:109], v[110:111]
    v_cvt_pk_bf16_f32 v96, 0, v96
    v_cvt_pk_bf16_f32 v97, 0, v97
    v_cvt_pk_bf16_f32 v100, 0, v100
    v_cvt_pk_bf16_f32 v101, 0, v101
    v_cvt_pk_bf16_f32 v104, 0, v104
    v_cvt_pk_bf16_f32 v105, 0, v105
    v_cvt_pk_bf16_f32 v108, 0, v108
    v_cvt_pk_bf16_f32 v109, 0, v109
    v_pk_mul_f32 v[98:99], v[52:53], v[42:43]
    v_pk_mul_f32 v[102:103], v[54:55], v[42:43]
    v_pk_mul_f32 v[106:107], v[56:57], v[42:43]
    v_pk_mul_f32 v[110:111], v[58:59], v[42:43]
    v_cvt_pk_bf16_f32 v98, 0, v98
    v_cvt_pk_bf16_f32 v99, 0, v99
    v_cvt_pk_bf16_f32 v102, 0, v102
    v_cvt_pk_bf16_f32 v103, 0, v103
    v_cvt_pk_bf16_f32 v106, 0, v106
    v_cvt_pk_bf16_f32 v107, 0, v107
    v_cvt_pk_bf16_f32 v110, 0, v110
    v_cvt_pk_bf16_f32 v111, 0, v111
    v_pk_add_f32 v[96:97], v[96:97], v[98:99]
    v_pk_add_f32 v[100:101], v[100:101], v[102:103]
    v_pk_add_f32 v[104:105], v[104:105], v[106:107]
    v_pk_add_f32 v[108:109], v[108:109], v[110:111]
    v_cvt_pk_bf16_f32 v96, 0, v96
    v_cvt_pk_bf16_f32 v97, 0, v97
    v_cvt_pk_bf16_f32 v100, 0, v100
    v_cvt_pk_bf16_f32 v101, 0, v101
    v_cvt_pk_bf16_f32 v104, 0, v104
    v_cvt_pk_bf16_f32 v105, 0, v105
    v_cvt_pk_bf16_f32 v108, 0, v108
    v_cvt_pk_bf16_f32 v109, 0, v109
    v_pk_mul_f32 v[98:99], v[54:55], v[40:41]
    v_pk_mul_f32 v[102:103], v[56:57], v[40:41]
    v_pk_mul_f32 v[106:107], v[58:59], v[40:41]
    v_pk_mul_f32 v[110:111], v[60:61], v[40:41]
    v_cvt_pk_bf16_f32 v98, 0, v98
    v_cvt_pk_bf16_f32 v99, 0, v99
    v_cvt_pk_bf16_f32 v102, 0, v102
    v_cvt_pk_bf16_f32 v103, 0, v103
    v_cvt_pk_bf16_f32 v106, 0, v106
    v_cvt_pk_bf16_f32 v107, 0, v107
    v_cvt_pk_bf16_f32 v110, 0, v110
    v_cvt_pk_bf16_f32 v111, 0, v111
    v_pk_add_f32 v[96:97], v[96:97], v[98:99]
    v_pk_add_f32 v[100:101], v[100:101], v[102:103]
    v_pk_add_f32 v[104:105], v[104:105], v[106:107]
    v_pk_add_f32 v[108:109], v[108:109], v[110:111]
    v_cvt_pk_bf16_f32 v96, 0, v96
    v_cvt_pk_bf16_f32 v97, 0, v97
    v_cvt_pk_bf16_f32 v100, 0, v100
    v_cvt_pk_bf16_f32 v101, 0, v101
    v_cvt_pk_bf16_f32 v104, 0, v104
    v_cvt_pk_bf16_f32 v105, 0, v105
    v_cvt_pk_bf16_f32 v108, 0, v108
    v_cvt_pk_bf16_f32 v109, 0, v109
    v_pk_mul_f32 v[96:97], v[96:97], v[72:73]
    v_pk_mul_f32 v[100:101], v[100:101], v[74:75]
    v_pk_mul_f32 v[104:105], v[104:105], v[76:77]
    v_pk_mul_f32 v[108:109], v[108:109], v[78:79]
    v_cvt_pk_bf16_f32 v123, v100, v96
    v_cvt_pk_bf16_f32 v127, v101, v97
    v_cvt_pk_bf16_f32 v122, v108, v104
    v_cvt_pk_bf16_f32 v126, v109, v105
    v_pk_mul_f32 v[96:97], v[56:57], v[46:47]
    v_pk_mul_f32 v[100:101], v[58:59], v[46:47]
    v_pk_mul_f32 v[104:105], v[60:61], v[46:47]
    v_pk_mul_f32 v[108:109], v[62:63], v[46:47]
    v_cvt_pk_bf16_f32 v96, 0, v96
    v_cvt_pk_bf16_f32 v97, 0, v97
    v_cvt_pk_bf16_f32 v100, 0, v100
    v_cvt_pk_bf16_f32 v101, 0, v101
    v_cvt_pk_bf16_f32 v104, 0, v104
    v_cvt_pk_bf16_f32 v105, 0, v105
    v_cvt_pk_bf16_f32 v108, 0, v108
    v_cvt_pk_bf16_f32 v109, 0, v109
    v_pk_mul_f32 v[98:99], v[58:59], v[44:45]
    v_pk_mul_f32 v[102:103], v[60:61], v[44:45]
    v_pk_mul_f32 v[106:107], v[62:63], v[44:45]
    v_pk_mul_f32 v[110:111], v[64:65], v[44:45]
    v_cvt_pk_bf16_f32 v98, 0, v98
    v_cvt_pk_bf16_f32 v99, 0, v99
    v_cvt_pk_bf16_f32 v102, 0, v102
    v_cvt_pk_bf16_f32 v103, 0, v103
    v_cvt_pk_bf16_f32 v106, 0, v106
    v_cvt_pk_bf16_f32 v107, 0, v107
    v_cvt_pk_bf16_f32 v110, 0, v110
    v_cvt_pk_bf16_f32 v111, 0, v111
    v_pk_add_f32 v[96:97], v[96:97], v[98:99]
    v_pk_add_f32 v[100:101], v[100:101], v[102:103]
    v_pk_add_f32 v[104:105], v[104:105], v[106:107]
    v_pk_add_f32 v[108:109], v[108:109], v[110:111]
    v_cvt_pk_bf16_f32 v96, 0, v96
    v_cvt_pk_bf16_f32 v97, 0, v97
    v_cvt_pk_bf16_f32 v100, 0, v100
    v_cvt_pk_bf16_f32 v101, 0, v101
    v_cvt_pk_bf16_f32 v104, 0, v104
    v_cvt_pk_bf16_f32 v105, 0, v105
    v_cvt_pk_bf16_f32 v108, 0, v108
    v_cvt_pk_bf16_f32 v109, 0, v109
    v_pk_mul_f32 v[98:99], v[60:61], v[42:43]
    v_pk_mul_f32 v[102:103], v[62:63], v[42:43]
    v_pk_mul_f32 v[106:107], v[64:65], v[42:43]
    v_pk_mul_f32 v[110:111], v[66:67], v[42:43]
    v_cvt_pk_bf16_f32 v98, 0, v98
    v_cvt_pk_bf16_f32 v99, 0, v99
    v_cvt_pk_bf16_f32 v102, 0, v102
    v_cvt_pk_bf16_f32 v103, 0, v103
    v_cvt_pk_bf16_f32 v106, 0, v106
    v_cvt_pk_bf16_f32 v107, 0, v107
    v_cvt_pk_bf16_f32 v110, 0, v110
    v_cvt_pk_bf16_f32 v111, 0, v111
    v_pk_add_f32 v[96:97], v[96:97], v[98:99]
    v_pk_add_f32 v[100:101], v[100:101], v[102:103]
    v_pk_add_f32 v[104:105], v[104:105], v[106:107]
    v_pk_add_f32 v[108:109], v[108:109], v[110:111]
    v_cvt_pk_bf16_f32 v96, 0, v96
    v_cvt_pk_bf16_f32 v97, 0, v97
    v_cvt_pk_bf16_f32 v100, 0, v100
    v_cvt_pk_bf16_f32 v101, 0, v101
    v_cvt_pk_bf16_f32 v104, 0, v104
    v_cvt_pk_bf16_f32 v105, 0, v105
    v_cvt_pk_bf16_f32 v108, 0, v108
    v_cvt_pk_bf16_f32 v109, 0, v109
    v_pk_mul_f32 v[98:99], v[62:63], v[40:41]
    v_pk_mul_f32 v[102:103], v[64:65], v[40:41]
    v_pk_mul_f32 v[106:107], v[66:67], v[40:41]
    v_pk_mul_f32 v[110:111], v[68:69], v[40:41]
    v_cvt_pk_bf16_f32 v98, 0, v98
    v_cvt_pk_bf16_f32 v99, 0, v99
    v_cvt_pk_bf16_f32 v102, 0, v102
    v_cvt_pk_bf16_f32 v103, 0, v103
    v_cvt_pk_bf16_f32 v106, 0, v106
    v_cvt_pk_bf16_f32 v107, 0, v107
    v_cvt_pk_bf16_f32 v110, 0, v110
    v_cvt_pk_bf16_f32 v111, 0, v111
    v_pk_add_f32 v[96:97], v[96:97], v[98:99]
    v_pk_add_f32 v[100:101], v[100:101], v[102:103]
    v_pk_add_f32 v[104:105], v[104:105], v[106:107]
    v_pk_add_f32 v[108:109], v[108:109], v[110:111]
    v_cvt_pk_bf16_f32 v96, 0, v96
    v_cvt_pk_bf16_f32 v97, 0, v97
    v_cvt_pk_bf16_f32 v100, 0, v100
    v_cvt_pk_bf16_f32 v101, 0, v101
    v_cvt_pk_bf16_f32 v104, 0, v104
    v_cvt_pk_bf16_f32 v105, 0, v105
    v_cvt_pk_bf16_f32 v108, 0, v108
    v_cvt_pk_bf16_f32 v109, 0, v109
    v_pk_mul_f32 v[96:97], v[96:97], v[80:81]
    v_pk_mul_f32 v[100:101], v[100:101], v[82:83]
    v_pk_mul_f32 v[104:105], v[104:105], v[84:85]
    v_pk_mul_f32 v[108:109], v[108:109], v[86:87]
    v_cvt_pk_bf16_f32 v121, v100, v96
    v_cvt_pk_bf16_f32 v125, v101, v97
    v_cvt_pk_bf16_f32 v120, v108, v104
    v_cvt_pk_bf16_f32 v124, v109, v105
    buffer_store_dwordx4 v[120:123], v10, s[52:55], s22 offen sc1
    buffer_store_dwordx4 v[124:127], v10, s[52:55], s23 offen sc1
    s_nop 1
    s_branch tl_34
td_35:
    s_waitcnt vmcnt(0)
    v_mov_b32 v12, 156700
    v_mov_b32 v13, 1
    s_mov_b64 exec, 1
    ds_add_rtn_u32 v13, v12, v13
    s_mov_b64 exec, -1
    s_waitcnt lgkmcnt(0)
    v_readfirstlane_b32 s24, v13
    s_nop 3
    s_cmp_lg_u32 s24, 6
    s_cbranch_scc1 nk_38
    s_mul_i32 s24, s30, 5
    s_lshr_b32 s25, s24, 5
    s_add_u32 s24, s24, 4
    s_lshr_b32 s24, s24, 5
    v_and_b32 v16, 63, v0
    v_mov_b32 v17, s24
    v_mov_b32 v18, s25
    v_cmp_gt_u32 vcc, 16, v16
    s_nop 1
    v_cndmask_b32 v17, v17, v18, vcc
    v_and_b32 v18, 15, v16
    v_lshl_add_u32 v18, v17, 4, v18
    v_lshlrev_b32 v19, 5, v17
    s_mov_b32 s24, 0x33333334
    v_mul_hi_u32 v19, v19, s24
    v_sub_u32 v19, s30, v19
    v_lshlrev_b32 v19, 2, v19
    v_lshl_add_u32 v18, v18, 9, v19
    v_add_u32 v18, 194624, v18
    v_mov_b32 v19, s28
    s_mov_b64 s[48:49], exec
    s_mov_b32 exec_hi, 0
    buffer_store_dword v19, v18, s[40:43], 0 offen sc1
    s_mov_b64 exec, s[48:49]
    s_lshl_b32 s24, s30, 7
    s_add_u32 s24, s24, 63488
    v_mov_b32 v16, s28
    v_mov_b32 v17, 0
    s_mov_b64 s[48:49], exec
    s_mov_b64 exec, 1
    buffer_store_dword v16, v17, s[40:43], s24 offen offset:0 sc1
    s_mov_b64 exec, s[48:49]
nk_38:
L_hend:
    s_waitcnt vmcnt(0) lgkmcnt(0)
    s_barrier
    s_cmp_ge_u32 s29, 4
    s_cbranch_scc1 L_convsel
    s_and_b32 s24, s2, 7
    s_lshr_b32 s25, s2, 3
    s_lshr_b32 s26, s24, 1
    s_lshl_b32 s26, s26, 3
    s_and_b32 s30, s25, 7
    s_add_u32 s30, s26, s30
    s_and_b32 s26, s24, 1
    s_lshl_b32 s26, s26, 2
    s_lshr_b32 s31, s25, 3
    s_add_u32 s31, s26, s31
    v_and_b32 v2, 63, v0
    v_lshlrev_b32 v3, 4, v2
    v_add_u32 v4, 4096, v3
    s_mul_i32 s24, s29, 12
    s_mul_i32 s25, s30, 48
    s_add_u32 s25, s25, s24
    s_lshl_b32 s32, s25, 12
    s_mul_i32 s25, s31, 48
    s_add_u32 s25, s25, s24
    s_mul_i32 s33, s25, 5120
    s_mov_b64 s[4:5], s[98:99]
    s_and_b32 s5, s5, 0xffff
    s_mov_b32 s6, 6291456
    s_mov_b32 s7, 0x00020000
    s_mov_b64 s[8:9], s[98:99]
    s_add_u32 s8, s8, 6291456
    s_addc_u32 s9, s9, 0
    s_and_b32 s9, s9, 0xffff
    s_mov_b32 s10, 1966080
    s_mov_b32 s11, 0x00020000
    s_mov_b64 s[12:13], s[72:73]
    s_and_b32 s13, s13, 0xffff
    s_mov_b32 s14, 2621440
    s_mov_b32 s15, 0x00020000
    s_mov_b64 s[16:17], s[98:99]
    s_add_u32 s16, s16, 10878976
    s_addc_u32 s17, s17, 0
    s_and_b32 s17, s17, 0xffff
    s_mov_b32 s18, 2621440
    s_mov_b32 s19, 0x00020000
    s_mov_b64 s[52:53], s[98:99]
    s_add_u32 s52, s52, 13500416
    s_addc_u32 s53, s53, 0
    s_and_b32 s53, s53, 0xffff
    s_mov_b32 s54, 16384
    s_mov_b32 s55, 0x00020000
    s_mov_b64 s[20:21], s[92:93]
    s_and_b32 s21, s21, 0xffff
    s_mov_b32 s22, 1280
    s_mov_b32 s23, 0x00020000
    v_and_b32 v5, 15, v2
    v_lshrrev_b32 v8, 4, v2
    s_lshl_b32 s24, s30, 6
    s_lshl_b32 s25, s29, 4
    s_add_u32 s24, s24, s25
    v_add_u32 v5, s24, v5
    v_lshlrev_b32 v9, 3, v5
    s_movk_i32 s26, 1280
    v_mul_lo_u32 v20, v5, s26
    s_mul_i32 s27, s31, 160
    v_lshlrev_b32 v21, 3, v8
    v_add_u32 v21, s27, v21
    v_add_u32 v20, v20, v21
    v_lshlrev_b32 v22, 7, v2
    s_cmp_lg_u32 s29, 0
    s_cbranch_scc1 w2o_39
    s_lshl_b32 s27, s2, 9
    s_add_u32 s27, s27, 194816
    s_mov_b32 s26, 0
sp_41:
    s_load_dwordx16 s[56:71], s[50:51], s27 glc
    s_waitcnt lgkmcnt(0)
    s_xor_b32 s48, s56, s28
    s_xor_b32 s49, s57, s28
    s_or_b32 s48, s48, s49
    s_xor_b32 s49, s58, s28
    s_or_b32 s48, s48, s49
    s_xor_b32 s49, s59, s28
    s_or_b32 s48, s48, s49
    s_xor_b32 s49, s60, s28
    s_or_b32 s48, s48, s49
    s_xor_b32 s49, s61, s28
    s_or_b32 s48, s48, s49
    s_xor_b32 s49, s62, s28
    s_or_b32 s48, s48, s49
    s_xor_b32 s49, s63, s28
    s_or_b32 s48, s48, s49
    s_xor_b32 s49, s64, s28
    s_or_b32 s48, s48, s49
    s_xor_b32 s49, s65, s28
    s_or_b32 s48, s48, s49
    s_xor_b32 s49, s66, s28
    s_or_b32 s48, s48, s49
    s_xor_b32 s49, s67, s28
    s_or_b32 s48, s48, s49
    s_xor_b32 s49, s68, s28
    s_or_b32 s48, s48, s49
    s_xor_b32 s49, s69, s28
    s_or_b32 s48, s48, s49
    s_xor_b32 s49, s70, s28
    s_or_b32 s48, s48, s49
    s_xor_b32 s49, s71, s28
    s_or_b32 s48, s48, s49
    s_cmp_eq_u32 s48, 0
    s_cbranch_scc1 spd_42
    s_sleep 2
    s_add_u32 s26, s26, 1
    s_cmp_lt_u32 s26, 40000
    s_cbranch_scc1 sp_41
    v_mov_b32 v250, 4
    v_mov_b32 v251, 0xdead
    buffer_store_dword v251, v250, s[44:47], 0 offen sc1
spd_42:
    s_add_u32 s27, s27, 64
    s_mov_b32 s26, 0
sp_43:
    s_load_dwordx16 s[56:71], s[50:51], s27 glc
    s_waitcnt lgkmcnt(0)
    s_xor_b32 s48, s56, s28
    s_xor_b32 s49, s57, s28
    s_or_b32 s48, s48, s49
    s_xor_b32 s49, s58, s28
    s_or_b32 s48, s48, s49
    s_xor_b32 s49, s59, s28
    s_or_b32 s48, s48, s49
    s_xor_b32 s49, s60, s28
    s_or_b32 s48, s48, s49
    s_xor_b32 s49, s61, s28
    s_or_b32 s48, s48, s49
    s_xor_b32 s49, s62, s28
    s_or_b32 s48, s48, s49
    s_xor_b32 s49, s63, s28
    s_or_b32 s48, s48, s49
    s_xor_b32 s49, s64, s28
    s_or_b32 s48, s48, s49
    s_xor_b32 s49, s65, s28
    s_or_b32 s48, s48, s49
    s_xor_b32 s49, s66, s28
    s_or_b32 s48, s48, s49
    s_xor_b32 s49, s67, s28
    s_or_b32 s48, s48, s49
    s_xor_b32 s49, s68, s28
    s_or_b32 s48, s48, s49
    s_xor_b32 s49, s69, s28
    s_or_b32 s48, s48, s49
    s_xor_b32 s49, s70, s28
    s_or_b32 s48, s48, s49
    s_xor_b32 s49, s71, s28
    s_or_b32 s48, s48, s49
    s_cmp_eq_u32 s48, 0
    s_cbranch_scc1 spd_44
    s_sleep 2
    s_add_u32 s26, s26, 1
    s_cmp_lt_u32 s26, 40000
    s_cbranch_scc1 sp_43
    v_mov_b32 v250, 4
    v_mov_b32 v251, 0xdead
    buffer_store_dword v251, v250, s[44:47], 0 offen sc1
spd_44:
    s_add_u32 s27, s27, 64
    s_mov_b32 s26, 0
sp_45:
    s_load_dwordx16 s[56:71], s[50:51], s27 glc
    s_waitcnt lgkmcnt(0)
    s_xor_b32 s48, s56, s28
    s_xor_b32 s49, s57, s28
    s_or_b32 s48, s48, s49
    s_xor_b32 s49, s58, s28
    s_or_b32 s48, s48, s49
    s_xor_b32 s49, s59, s28
    s_or_b32 s48, s48, s49
    s_xor_b32 s49, s60, s28
    s_or_b32 s48, s48, s49
    s_xor_b32 s49, s61, s28
    s_or_b32 s48, s48, s49
    s_xor_b32 s49, s62, s28
    s_or_b32 s48, s48, s49
    s_xor_b32 s49, s63, s28
    s_or_b32 s48, s48, s49
    s_xor_b32 s49, s64, s28
    s_or_b32 s48, s48, s49
    s_xor_b32 s49, s65, s28
    s_or_b32 s48, s48, s49
    s_xor_b32 s49, s66, s28
    s_or_b32 s48, s48, s49
    s_xor_b32 s49, s67, s28
    s_or_b32 s48, s48, s49
    s_xor_b32 s49, s68, s28
    s_or_b32 s48, s48, s49
    s_xor_b32 s49, s69, s28
    s_or_b32 s48, s48, s49
    s_xor_b32 s49, s70, s28
    s_or_b32 s48, s48, s49
    s_xor_b32 s49, s71, s28
    s_or_b32 s48, s48, s49
    s_cmp_eq_u32 s48, 0
    s_cbranch_scc1 spd_46
    s_sleep 2
    s_add_u32 s26, s26, 1
    s_cmp_lt_u32 s26, 40000
    s_cbranch_scc1 sp_45
    v_mov_b32 v250, 4
    v_mov_b32 v251, 0xdead
    buffer_store_dword v251, v250, s[44:47], 0 offen sc1
spd_46:
    v_mov_b32 v24, 156676
    v_mov_b32 v25, 1
    s_mov_b64 s[48:49], exec
    s_mov_b64 exec, 1
    ds_write_b32 v24, v25
    s_mov_b64 exec, s[48:49]
    s_branch w2j_40
w2o_39:
    s_mov_b32 s26, 0
    v_mov_b32 v24, 156676
ldsw_47:
    ds_read_b32 v25, v24
    s_waitcnt lgkmcnt(0)
    v_readfirstlane_b32 s24, v25
    s_nop 3
    s_cmp_lg_u32 s24, 0
    s_cbranch_scc1 ldswd_48
    s_sleep 2
    s_add_u32 s26, s26, 1
    s_cmp_lt_u32 s26, 800000
    s_cbranch_scc1 ldsw_47
    v_mov_b32 v250, 4
    v_mov_b32 v251, 0xdead
    buffer_store_dword v251, v250, s[44:47], 0 offen sc1
ldswd_48:
w2j_40:
    buffer_load_dwordx4 v[120:123], v3, s[8:11], s33 offen offset:0 sc1
    buffer_load_dwordx4 v[124:127], v3, s[8:11], s33 offen offset:1024 sc1
    buffer_load_dwordx4 v[128:131], v3, s[8:11], s33 offen offset:2048 sc1
    buffer_load_dwordx4 v[132:135], v3, s[8:11], s33 offen offset:3072 sc1
    buffer_load_dwordx4 v[136:139], v4, s[8:11], s33 offen sc1
    s_add_u32 s33, s33, 5120
    buffer_load_dwordx4 v[156:159], v3, s[8:11], s33 offen offset:0 sc1
    buffer_load_dwordx4 v[160:163], v3, s[8:11], s33 offen offset:1024 sc1
    buffer_load_dwordx4 v[164:167], v3, s[8:11], s33 offen offset:2048 sc1
    buffer_load_dwordx4 v[168:171], v3, s[8:11], s33 offen offset:3072 sc1
    buffer_load_dwordx4 v[172:175], v4, s[8:11], s33 offen sc1
    s_add_u32 s33, s33, 5120
    buffer_load_dwordx4 v[192:195], v3, s[8:11], s33 offen offset:0 sc1
    buffer_load_dwordx4 v[196:199], v3, s[8:11], s33 offen offset:1024 sc1
    buffer_load_dwordx4 v[200:203], v3, s[8:11], s33 offen offset:2048 sc1
    buffer_load_dwordx4 v[204:207], v3, s[8:11], s33 offen offset:3072 sc1
    buffer_load_dwordx4 v[208:211], v4, s[8:11], s33 offen sc1
    s_add_u32 s33, s33, 5120
    buffer_load_dwordx4 v[228:231], v3, s[8:11], s33 offen offset:0 sc1
    buffer_load_dwordx4 v[232:235], v3, s[8:11], s33 offen offset:1024 sc1
    buffer_load_dwordx4 v[236:239], v3, s[8:11], s33 offen offset:2048 sc1
    buffer_load_dwordx4 v[240:243], v3, s[8:11], s33 offen offset:3072 sc1
    buffer_load_dwordx4 v[244:247], v4, s[8:11], s33 offen sc1
    s_add_u32 s33, s33, 5120
    s_branch L_gemm2
L_convsel:
    s_cmp_ge_u32 s2, 160
    s_cbranch_scc1 L_convdone
    s_sub_u32 s27, s29, 4
    s_waitcnt vmcnt(0)
    v_and_b32 v2, 63, v0
    s_sub_u32 s20, s29, 4
    s_lshl_b32 s21, s2, 2
    s_add_u32 s21, s21, s20
    s_mul_i32 s22, s20, 21248
    s_lshl_b32 s23, s21, 12
    v_lshlrev_b32 v5, 4, v2
    v_mov_b32 v4, v94
    v_cmp_eq_u32 vcc, 0, v2
    v_mov_b32 v46, 0
    v_mov_b32 v47, 0
    v_lshlrev_b32 v13, 3, v2
    v_add_u32 v13, s22, v13
    ds_write_b64 v13, v[46:47] offset:20736
    v_add_u32 v14, s22, v5
    v_mov_b32 v15, 4112
    v_cndmask_b32 v15, 0, v15, vcc
    v_add_u32 v15, s22, v15
    v_mov_b32_dpp v116, v100 wave_shr:1 row_mask:0xf bank_mask:0xf bound_ctrl:0
    v_mov_b32_dpp v117, v101 wave_shr:1 row_mask:0xf bank_mask:0xf bound_ctrl:0
    v_mov_b32_dpp v118, v102 wave_shr:1 row_mask:0xf bank_mask:0xf bound_ctrl:0
    v_mov_b32_dpp v119, v103 wave_shr:1 row_mask:0xf bank_mask:0xf bound_ctrl:0
    v_mov_b32 v120, v100
    v_mov_b32 v121, v101
    v_alignbit_b32 v48, v117, v116, 16
    v_alignbit_b32 v49, v118, v117, 16
    v_alignbit_b32 v50, v119, v118, 16
    v_alignbit_b32 v51, v120, v119, 16
    v_alignbit_b32 v52, v121, v120, 16
    ds_write_b128 v14, v[48:51] offset:16
    v_mov_b32 v54, v117
    v_mov_b32 v55, v118
    v_mov_b32 v56, v119
    v_mov_b32 v57, v120
    ds_write_b128 v14, v[54:57] offset:4176
    v_mov_b32 v58, v49
    v_mov_b32 v59, v50
    v_mov_b32 v60, v51
    v_mov_b32 v61, v52
    ds_write_b128 v14, v[58:61] offset:8336
    ds_write_b128 v14, v[118:121] offset:12496
    v_mov_b32_dpp v122, v104 wave_shr:1 row_mask:0xf bank_mask:0xf bound_ctrl:0
    v_mov_b32_dpp v123, v105 wave_shr:1 row_mask:0xf bank_mask:0xf bound_ctrl:0
    v_mov_b32_dpp v124, v106 wave_shr:1 row_mask:0xf bank_mask:0xf bound_ctrl:0
    v_mov_b32_dpp v125, v107 wave_shr:1 row_mask:0xf bank_mask:0xf bound_ctrl:0
    v_mov_b32 v126, v104
    v_mov_b32 v127, v105
    v_readlane_b32 s56, v100, 63
    v_readlane_b32 s57, v101, 63
    v_readlane_b32 s58, v102, 63
    v_readlane_b32 s59, v103, 63
    v_writelane_b32 v122, s56, 0
    v_writelane_b32 v123, s57, 0
    v_writelane_b32 v124, s58, 0
    v_writelane_b32 v125, s59, 0
    v_alignbit_b32 v48, v123, v122, 16
    v_alignbit_b32 v49, v124, v123, 16
    v_alignbit_b32 v50, v125, v124, 16
    v_alignbit_b32 v51, v126, v125, 16
    v_alignbit_b32 v52, v127, v126, 16
    ds_write_b128 v14, v[48:51] offset:1040
    v_mov_b32 v54, v123
    v_mov_b32 v55, v124
    v_mov_b32 v56, v125
    v_mov_b32 v57, v126
    ds_write_b128 v14, v[54:57] offset:5200
    v_mov_b32 v58, v49
    v_mov_b32 v59, v50
    v_mov_b32 v60, v51
    v_mov_b32 v61, v52
    ds_write_b128 v14, v[58:61] offset:9360
    ds_write_b128 v14, v[124:127] offset:13520
    v_mov_b32_dpp v116, v108 wave_shr:1 row_mask:0xf bank_mask:0xf bound_ctrl:0
    v_mov_b32_dpp v117, v109 wave_shr:1 row_mask:0xf bank_mask:0xf bound_ctrl:0
    v_mov_b32_dpp v118, v110 wave_shr:1 row_mask:0xf bank_mask:0xf bound_ctrl:0
    v_mov_b32_dpp v119, v111 wave_shr:1 row_mask:0xf bank_mask:0xf bound_ctrl:0
    v_mov_b32 v120, v108
    v_mov_b32 v121, v109
    v_readlane_b32 s56, v104, 63
    v_readlane_b32 s57, v105, 63
    v_readlane_b32 s58, v106, 63
    v_readlane_b32 s59, v107, 63
    v_writelane_b32 v116, s56, 0
    v_writelane_b32 v117, s57, 0
    v_writelane_b32 v118, s58, 0
    v_writelane_b32 v119, s59, 0
    v_alignbit_b32 v48, v117, v116, 16
    v_alignbit_b32 v49, v118, v117, 16
    v_alignbit_b32 v50, v119, v118, 16
    v_alignbit_b32 v51, v120, v119, 16
    v_alignbit_b32 v52, v121, v120, 16
    ds_write_b128 v14, v[48:51] offset:2064
    v_mov_b32 v54, v117
    v_mov_b32 v55, v118
    v_mov_b32 v56, v119
    v_mov_b32 v57, v120
    ds_write_b128 v14, v[54:57] offset:6224
    v_mov_b32 v58, v49
    v_mov_b32 v59, v50
    v_mov_b32 v60, v51
    v_mov_b32 v61, v52
    ds_write_b128 v14, v[58:61] offset:10384
    ds_write_b128 v14, v[118:121] offset:14544
    v_mov_b32_dpp v122, v112 wave_shr:1 row_mask:0xf bank_mask:0xf bound_ctrl:0
    v_mov_b32_dpp v123, v113 wave_shr:1 row_mask:0xf bank_mask:0xf bound_ctrl:0
    v_mov_b32_dpp v124, v114 wave_shr:1 row_mask:0xf bank_mask:0xf bound_ctrl:0
    v_mov_b32_dpp v125, v115 wave_shr:1 row_mask:0xf bank_mask:0xf bound_ctrl:0
    v_mov_b32 v126, v112
    v_mov_b32 v127, v113
    v_readlane_b32 s56, v108, 63
    v_readlane_b32 s57, v109, 63
    v_readlane_b32 s58, v110, 63
    v_readlane_b32 s59, v111, 63
    v_writelane_b32 v122, s56, 0
    v_writelane_b32 v123, s57, 0
    v_writelane_b32 v124, s58, 0
    v_writelane_b32 v125, s59, 0
    v_alignbit_b32 v48, v123, v122, 16
    v_alignbit_b32 v49, v124, v123, 16
    v_alignbit_b32 v50, v125, v124, 16
    v_alignbit_b32 v51, v126, v125, 16
    v_alignbit_b32 v52, v127, v126, 16
    ds_write_b128 v14, v[48:51] offset:3088
    v_mov_b32 v54, v123
    v_mov_b32 v55, v124
    v_mov_b32 v56, v125
    v_mov_b32 v57, v126
    ds_write_b128 v14, v[54:57] offset:7248
    v_mov_b32 v58, v49
    v_mov_b32 v59, v50
    v_mov_b32 v60, v51
    v_mov_b32 v61, v52
    ds_write_b128 v14, v[58:61] offset:11408
    ds_write_b128 v14, v[124:127] offset:15568
    v_mov_b32 v116, 0
    v_mov_b32 v117, 0
    v_mov_b32 v118, 0
    v_mov_b32 v119, 0
    v_mov_b32 v120, 0
    v_mov_b32 v121, 0
    v_readlane_b32 s56, v112, 63
    v_readlane_b32 s57, v113, 63
    v_readlane_b32 s58, v114, 63
    v_readlane_b32 s59, v115, 63
    v_writelane_b32 v116, s56, 0
    v_writelane_b32 v117, s57, 0
    v_writelane_b32 v118, s58, 0
    v_writelane_b32 v119, s59, 0
    v_alignbit_b32 v48, v117, v116, 16
    v_alignbit_b32 v49, v118, v117, 16
    v_alignbit_b32 v50, v119, v118, 16
    v_alignbit_b32 v51, v120, v119, 16
    v_alignbit_b32 v52, v121, v120, 16
    s_mov_b64 exec, 3
    ds_write_b128 v15, v[48:51] offset:0
    v_mov_b32 v54, v117
    v_mov_b32 v55, v118
    v_mov_b32 v56, v119
    v_mov_b32 v57, v120
    ds_write_b128 v15, v[54:57] offset:4160
    v_mov_b32 v58, v49
    v_mov_b32 v59, v50
    v_mov_b32 v60, v51
    v_mov_b32 v61, v52
    ds_write_b128 v15, v[58:61] offset:8320
    ds_write_b128 v15, v[118:121] offset:12480
    s_mov_b64 exec, -1
    s_waitcnt lgkmcnt(0)
    s_mov_b64 s[8:9], s[98:99]
    s_add_u32 s8, s8, 8257536
    s_addc_u32 s9, s9, 0
    s_and_b32 s9, s9, 0xffff
    s_mov_b32 s10, 2621440
    s_mov_b32 s11, 0x00020000
    s_mov_b64 s[12:13], s[98:99]
    s_add_u32 s12, s12, 10878976
    s_addc_u32 s13, s13, 0
    s_and_b32 s13, s13, 0xffff
    s_mov_b32 s14, 2621440
    s_mov_b32 s15, 0x00020000
    s_cmp_lg_u32 s29, 4
    s_cbranch_scc1 kvo_49
    s_lshr_b32 s24, s21, 6
    s_lshl_b32 s24, s24, 5
    s_add_u32 s25, s24, 31
    s_mul_hi_u32 s24, s24, 0x33333334
    s_mul_hi_u32 s25, s25, 0x33333334
    s_sub_u32 s69, s25, s24
    s_lshl_b32 s24, s2, 9
    s_add_u32 s68, s24, 194624
    s_mov_b32 s26, 0
kvp_51:
    s_load_dwordx8 s[56:63], s[50:51], s68 glc
    s_waitcnt lgkmcnt(0)
    s_cmp_eq_u32 s69, 6
    s_cselect_b32 s63, s28, s63
    s_xor_b32 s48, s56, s28
    s_xor_b32 s49, s57, s28
    s_or_b32 s48, s48, s49
    s_xor_b32 s49, s58, s28
    s_or_b32 s48, s48, s49
    s_xor_b32 s49, s59, s28
    s_or_b32 s48, s48, s49
    s_xor_b32 s49, s60, s28
    s_or_b32 s48, s48, s49
    s_xor_b32 s49, s61, s28
    s_or_b32 s48, s48, s49
    s_xor_b32 s49, s62, s28
    s_or_b32 s48, s48, s49
    s_xor_b32 s49, s63, s28
    s_or_b32 s48, s48, s49
    s_cmp_eq_u32 s48, 0
    s_cbranch_scc1 kvpd_52
    s_sleep 2
    s_add_u32 s26, s26, 1
    s_cmp_lt_u32 s26, 40000
    s_cbranch_scc1 kvp_51
    v_mov_b32 v250, 4
    v_mov_b32 v251, 0xdead
    buffer_store_dword v251, v250, s[44:47], 0 offen sc1
kvpd_52:
    v_mov_b32 v16, 156680
    v_mov_b32 v17, 1
    s_mov_b64 s[48:49], exec
    s_mov_b64 exec, 1
    ds_write_b32 v16, v17
    s_mov_b64 exec, s[48:49]
    s_branch kvj_50
kvo_49:
    s_mov_b32 s26, 0
    v_mov_b32 v16, 156680
ldsw_53:
    ds_read_b32 v17, v16
    s_waitcnt lgkmcnt(0)
    v_readfirstlane_b32 s24, v17
    s_nop 3
    s_cmp_lg_u32 s24, 0
    s_cbranch_scc1 ldswd_54
    s_sleep 2
    s_add_u32 s26, s26, 1
    s_cmp_lt_u32 s26, 800000
    s_cbranch_scc1 ldsw_53
    v_mov_b32 v250, 4
    v_mov_b32 v251, 0xdead
    buffer_store_dword v251, v250, s[44:47], 0 offen sc1
ldswd_54:
kvj_50:
    s_add_u32 s25, s23, 0
    buffer_load_dwordx4 v[16:19], v5, s[8:11], s25 offen sc1
    s_add_u32 s25, s23, 1024
    buffer_load_dwordx4 v[20:23], v5, s[8:11], s25 offen sc1
    s_add_u32 s25, s23, 2048
    buffer_load_dwordx4 v[24:27], v5, s[8:11], s25 offen sc1
    s_add_u32 s25, s23, 3072
    buffer_load_dwordx4 v[28:31], v5, s[8:11], s25 offen sc1
    v_and_b32 v6, 15, v2
    v_lshrrev_b32 v7, 4, v2
    v_and_b32 v8, 3, v6
    v_mul_u32_u24 v8, 4160, v8
    v_and_b32 v9, 12, v6
    v_lshlrev_b32 v9, 1, v9
    v_lshl_add_u32 v9, v7, 4, v9
    v_add3_u32 v10, v8, v9, s22
    v_lshlrev_b32 v8, 5, v6
    v_lshlrev_b32 v9, 4, v7
    v_sub_u32 v9, v9, v8
    v_add_u32 v9, 17120, v9
    v_add_u32 v11, s22, v9
    v_lshlrev_b32 v9, 3, v7
    v_add_u32 v12, v8, v9
    v_sub_u32 v13, 17144, v12
    v_add_u32 v13, s22, v13
    v_and_b32 v9, 1, v7
    v_lshlrev_b32 v9, 9, v9
    v_add_u32 v9, v9, v8
    v_lshrrev_b32 v12, 1, v7
    v_lshl_add_u32 v12, v12, 4, v9
    s_waitcnt vmcnt(3)
    ds_write_b128 v14, v[16:19] offset:16640
    s_waitcnt vmcnt(2)
    ds_write_b128 v14, v[20:23] offset:17664
    s_waitcnt vmcnt(1)
    ds_write_b128 v14, v[24:27] offset:18688
    s_waitcnt vmcnt(0)
    ds_write_b128 v14, v[28:31] offset:19712
    s_waitcnt lgkmcnt(0)
    s_setprio 2
    ds_read_b64 v[64:65], v10 offset:0
    ds_read_b128 v[96:99], v11 offset:3584
    ds_read_b64 v[66:67], v10 offset:8
    ds_read_b64 v[68:69], v10 offset:512
    ds_read_b128 v[100:103], v11 offset:3072
    ds_read_b64 v[70:71], v10 offset:520
    ds_read_b64 v[72:73], v10 offset:1024
    ds_read_b128 v[104:107], v11 offset:2560
    ds_read_b64 v[74:75], v10 offset:1032
    ds_read_b64 v[76:77], v10 offset:1536
    ds_read_b128 v[108:111], v11 offset:2048
    ds_read_b64 v[78:79], v10 offset:1544
    ds_read_b64 v[80:81], v10 offset:2048
    ds_read_b128 v[112:115], v11 offset:1536
    ds_read_b64 v[82:83], v10 offset:2056
    ds_read_b64 v[84:85], v10 offset:2560
    ds_read_b128 v[116:119], v11 offset:1024
    ds_read_b64 v[86:87], v10 offset:2568
    ds_read_b64 v[88:89], v10 offset:3072
    ds_read_b128 v[120:123], v11 offset:512
    ds_read_b64 v[90:91], v10 offset:3080
    ds_read_b64 v[92:93], v10 offset:3584
    ds_read_b128 v[124:127], v11 offset:0
    ds_read_b64 v[94:95], v10 offset:3592
    s_waitcnt lgkmcnt(0)
    v_mfma_f32_16x16x32_bf16 v[192:195], v[64:67], v[96:99], 0
    ds_read_b64 v[128:129], v10 offset:64
    v_mfma_f32_16x16x32_bf16 v[196:199], v[64:67], v[100:103], 0
    ds_read_b128 v[160:163], v11 offset:3648
    v_mfma_f32_16x16x32_bf16 v[200:203], v[64:67], v[104:107], 0
    ds_read_b64 v[130:131], v10 offset:72
    v_mfma_f32_16x16x32_bf16 v[204:207], v[64:67], v[108:111], 0
    ds_read_b64 v[132:133], v10 offset:576
    v_mfma_f32_16x16x32_bf16 v[208:211], v[64:67], v[112:115], 0
    ds_read_b128 v[164:167], v11 offset:3136
    v_mfma_f32_16x16x32_bf16 v[212:215], v[64:67], v[116:119], 0
    ds_read_b64 v[134:135], v10 offset:584
    v_mfma_f32_16x16x32_bf16 v[216:219], v[64:67], v[120:123], 0
    ds_read_b64 v[136:137], v10 offset:1088
    v_mfma_f32_16x16x32_bf16 v[220:223], v[64:67], v[124:127], 0
    ds_read_b128 v[168:171], v11 offset:2624
    v_mfma_f32_16x16x32_bf16 v[196:199], v[68:71], v[96:99], v[196:199]
    ds_read_b64 v[138:139], v10 offset:1096
    v_mfma_f32_16x16x32_bf16 v[200:203], v[68:71], v[100:103], v[200:203]
    ds_read_b64 v[140:141], v10 offset:1600
    v_mfma_f32_16x16x32_bf16 v[204:207], v[68:71], v[104:107], v[204:207]
    ds_read_b128 v[172:175], v11 offset:2112
    v_mfma_f32_16x16x32_bf16 v[208:211], v[68:71], v[108:111], v[208:211]
    ds_read_b64 v[142:143], v10 offset:1608
    v_mfma_f32_16x16x32_bf16 v[212:215], v[68:71], v[112:115], v[212:215]
    ds_read_b64 v[144:145], v10 offset:2112
    v_mfma_f32_16x16x32_bf16 v[216:219], v[68:71], v[116:119], v[216:219]
    ds_read_b128 v[176:179], v11 offset:1600
    v_mfma_f32_16x16x32_bf16 v[220:223], v[68:71], v[120:123], v[220:223]
    ds_read_b64 v[146:147], v10 offset:2120
    v_mfma_f32_16x16x32_bf16 v[200:203], v[72:75], v[96:99], v[200:203]
    ds_read_b64 v[148:149], v10 offset:2624
    v_mfma_f32_16x16x32_bf16 v[204:207], v[72:75], v[100:103], v[204:207]
    ds_read_b128 v[180:183], v11 offset:1088
    v_mfma_f32_16x16x32_bf16 v[208:211], v[72:75], v[104:107], v[208:211]
    ds_read_b64 v[150:151], v10 offset:2632
    v_mfma_f32_16x16x32_bf16 v[212:215], v[72:75], v[108:111], v[212:215]
    ds_read_b64 v[152:153], v10 offset:3136
    v_mfma_f32_16x16x32_bf16 v[216:219], v[72:75], v[112:115], v[216:219]
    ds_read_b128 v[184:187], v11 offset:576
    v_mfma_f32_16x16x32_bf16 v[220:223], v[72:75], v[116:119], v[220:223]
    ds_read_b64 v[154:155], v10 offset:3144
    v_mfma_f32_16x16x32_bf16 v[204:207], v[76:79], v[96:99], v[204:207]
    ds_read_b64 v[156:157], v10 offset:3648
    v_mfma_f32_16x16x32_bf16 v[208:211], v[76:79], v[100:103], v[208:211]
    ds_read_b128 v[188:191], v11 offset:64
    v_mfma_f32_16x16x32_bf16 v[212:215], v[76:79], v[104:107], v[212:215]
    ds_read_b64 v[158:159], v10 offset:3656
    v_mfma_f32_16x16x32_bf16 v[216:219], v[76:79], v[108:111], v[216:219]
    v_mfma_f32_16x16x32_bf16 v[220:223], v[76:79], v[112:115], v[220:223]
    v_mfma_f32_16x16x32_bf16 v[208:211], v[80:83], v[96:99], v[208:211]
    v_mfma_f32_16x16x32_bf16 v[212:215], v[80:83], v[100:103], v[212:215]
    v_mfma_f32_16x16x32_bf16 v[216:219], v[80:83], v[104:107], v[216:219]
    v_mfma_f32_16x16x32_bf16 v[220:223], v[80:83], v[108:111], v[220:223]
    v_mfma_f32_16x16x32_bf16 v[212:215], v[84:87], v[96:99], v[212:215]
    v_mfma_f32_16x16x32_bf16 v[216:219], v[84:87], v[100:103], v[216:219]
    v_mfma_f32_16x16x32_bf16 v[220:223], v[84:87], v[104:107], v[220:223]
    v_mfma_f32_16x16x32_bf16 v[216:219], v[88:91], v[96:99], v[216:219]
    v_mfma_f32_16x16x32_bf16 v[220:223], v[88:91], v[100:103], v[220:223]
    v_mfma_f32_16x16x32_bf16 v[220:223], v[92:95], v[96:99], v[220:223]
    s_waitcnt lgkmcnt(0)
    v_mfma_f32_16x16x32_bf16 v[192:195], v[128:131], v[160:163], v[192:195]
    ds_read_b64 v[64:65], v10 offset:128
    v_mfma_f32_16x16x32_bf16 v[196:199], v[128:131], v[164:167], v[196:199]
    ds_read_b128 v[96:99], v11 offset:3712
    v_mfma_f32_16x16x32_bf16 v[200:203], v[128:131], v[168:171], v[200:203]
    ds_read_b64 v[66:67], v10 offset:136
    v_mfma_f32_16x16x32_bf16 v[204:207], v[128:131], v[172:175], v[204:207]
    ds_read_b64 v[68:69], v10 offset:640
    v_mfma_f32_16x16x32_bf16 v[208:211], v[128:131], v[176:179], v[208:211]
    ds_read_b128 v[100:103], v11 offset:3200
    v_mfma_f32_16x16x32_bf16 v[212:215], v[128:131], v[180:183], v[212:215]
    ds_read_b64 v[70:71], v10 offset:648
    v_mfma_f32_16x16x32_bf16 v[216:219], v[128:131], v[184:187], v[216:219]
    ds_read_b64 v[72:73], v10 offset:1152
    v_mfma_f32_16x16x32_bf16 v[220:223], v[128:131], v[188:191], v[220:223]
    ds_read_b128 v[104:107], v11 offset:2688
    v_mfma_f32_16x16x32_bf16 v[196:199], v[132:135], v[160:163], v[196:199]
    ds_read_b64 v[74:75], v10 offset:1160
    v_mfma_f32_16x16x32_bf16 v[200:203], v[132:135], v[164:167], v[200:203]
    ds_read_b64 v[76:77], v10 offset:1664
    v_mfma_f32_16x16x32_bf16 v[204:207], v[132:135], v[168:171], v[204:207]
    ds_read_b128 v[108:111], v11 offset:2176
    v_mfma_f32_16x16x32_bf16 v[208:211], v[132:135], v[172:175], v[208:211]
    ds_read_b64 v[78:79], v10 offset:1672
    v_mfma_f32_16x16x32_bf16 v[212:215], v[132:135], v[176:179], v[212:215]
    ds_read_b64 v[80:81], v10 offset:2176
    v_mfma_f32_16x16x32_bf16 v[216:219], v[132:135], v[180:183], v[216:219]
    ds_read_b128 v[112:115], v11 offset:1664
    v_mfma_f32_16x16x32_bf16 v[220:223], v[132:135], v[184:187], v[220:223]
    ds_read_b64 v[82:83], v10 offset:2184
    v_mfma_f32_16x16x32_bf16 v[200:203], v[136:139], v[160:163], v[200:203]
    ds_read_b64 v[84:85], v10 offset:2688
    v_mfma_f32_16x16x32_bf16 v[204:207], v[136:139], v[164:167], v[204:207]
    ds_read_b128 v[116:119], v11 offset:1152
    v_mfma_f32_16x16x32_bf16 v[208:211], v[136:139], v[168:171], v[208:211]
    ds_read_b64 v[86:87], v10 offset:2696
    v_mfma_f32_16x16x32_bf16 v[212:215], v[136:139], v[172:175], v[212:215]
    ds_read_b64 v[88:89], v10 offset:3200
    v_mfma_f32_16x16x32_bf16 v[216:219], v[136:139], v[176:179], v[216:219]
    ds_read_b128 v[120:123], v11 offset:640
    v_mfma_f32_16x16x32_bf16 v[220:223], v[136:139], v[180:183], v[220:223]
    ds_read_b64 v[90:91], v10 offset:3208
    v_mfma_f32_16x16x32_bf16 v[204:207], v[140:143], v[160:163], v[204:207]
    ds_read_b64 v[92:93], v10 offset:3712
    v_mfma_f32_16x16x32_bf16 v[208:211], v[140:143], v[164:167], v[208:211]
    ds_read_b128 v[124:127], v11 offset:128
    v_mfma_f32_16x16x32_bf16 v[212:215], v[140:143], v[168:171], v[212:215]
    ds_read_b64 v[94:95], v10 offset:3720
    v_mfma_f32_16x16x32_bf16 v[216:219], v[140:143], v[172:175], v[216:219]
    v_mfma_f32_16x16x32_bf16 v[220:223], v[140:143], v[176:179], v[220:223]
    v_mfma_f32_16x16x32_bf16 v[208:211], v[144:147], v[160:163], v[208:211]
    v_mfma_f32_16x16x32_bf16 v[212:215], v[144:147], v[164:167], v[212:215]
    v_mfma_f32_16x16x32_bf16 v[216:219], v[144:147], v[168:171], v[216:219]
    v_mfma_f32_16x16x32_bf16 v[220:223], v[144:147], v[172:175], v[220:223]
    v_mfma_f32_16x16x32_bf16 v[212:215], v[148:151], v[160:163], v[212:215]
    v_mfma_f32_16x16x32_bf16 v[216:219], v[148:151], v[164:167], v[216:219]
    v_mfma_f32_16x16x32_bf16 v[220:223], v[148:151], v[168:171], v[220:223]
    v_mfma_f32_16x16x32_bf16 v[216:219], v[152:155], v[160:163], v[216:219]
    v_mfma_f32_16x16x32_bf16 v[220:223], v[152:155], v[164:167], v[220:223]
    v_mfma_f32_16x16x32_bf16 v[220:223], v[156:159], v[160:163], v[220:223]
    s_waitcnt lgkmcnt(0)
    v_mfma_f32_16x16x32_bf16 v[192:195], v[64:67], v[96:99], v[192:195]
    ds_read_b64 v[128:129], v10 offset:192
    v_mfma_f32_16x16x32_bf16 v[196:199], v[64:67], v[100:103], v[196:199]
    ds_read_b128 v[160:163], v11 offset:3776
    v_mfma_f32_16x16x32_bf16 v[200:203], v[64:67], v[104:107], v[200:203]
    ds_read_b64 v[130:131], v10 offset:200
    v_mfma_f32_16x16x32_bf16 v[204:207], v[64:67], v[108:111], v[204:207]
    ds_read_b64 v[132:133], v10 offset:704
    v_mfma_f32_16x16x32_bf16 v[208:211], v[64:67], v[112:115], v[208:211]
    ds_read_b128 v[164:167], v11 offset:3264
    v_mfma_f32_16x16x32_bf16 v[212:215], v[64:67], v[116:119], v[212:215]
    ds_read_b64 v[134:135], v10 offset:712
    v_mfma_f32_16x16x32_bf16 v[216:219], v[64:67], v[120:123], v[216:219]
    ds_read_b64 v[136:137], v10 offset:1216
    v_mfma_f32_16x16x32_bf16 v[220:223], v[64:67], v[124:127], v[220:223]
    ds_read_b128 v[168:171], v11 offset:2752
    v_mfma_f32_16x16x32_bf16 v[196:199], v[68:71], v[96:99], v[196:199]
    ds_read_b64 v[138:139], v10 offset:1224
    v_mfma_f32_16x16x32_bf16 v[200:203], v[68:71], v[100:103], v[200:203]
    ds_read_b64 v[140:141], v10 offset:1728
    v_mfma_f32_16x16x32_bf16 v[204:207], v[68:71], v[104:107], v[204:207]
    ds_read_b128 v[172:175], v11 offset:2240
    v_mfma_f32_16x16x32_bf16 v[208:211], v[68:71], v[108:111], v[208:211]
    ds_read_b64 v[142:143], v10 offset:1736
    v_mfma_f32_16x16x32_bf16 v[212:215], v[68:71], v[112:115], v[212:215]
    ds_read_b64 v[144:145], v10 offset:2240
    v_mfma_f32_16x16x32_bf16 v[216:219], v[68:71], v[116:119], v[216:219]
    ds_read_b128 v[176:179], v11 offset:1728
    v_mfma_f32_16x16x32_bf16 v[220:223], v[68:71], v[120:123], v[220:223]
    ds_read_b64 v[146:147], v10 offset:2248
    v_mfma_f32_16x16x32_bf16 v[200:203], v[72:75], v[96:99], v[200:203]
    ds_read_b64 v[148:149], v10 offset:2752
    v_mfma_f32_16x16x32_bf16 v[204:207], v[72:75], v[100:103], v[204:207]
    ds_read_b128 v[180:183], v11 offset:1216
    v_mfma_f32_16x16x32_bf16 v[208:211], v[72:75], v[104:107], v[208:211]
    ds_read_b64 v[150:151], v10 offset:2760
    v_mfma_f32_16x16x32_bf16 v[212:215], v[72:75], v[108:111], v[212:215]
    ds_read_b64 v[152:153], v10 offset:3264
    v_mfma_f32_16x16x32_bf16 v[216:219], v[72:75], v[112:115], v[216:219]
    ds_read_b128 v[184:187], v11 offset:704
    v_mfma_f32_16x16x32_bf16 v[220:223], v[72:75], v[116:119], v[220:223]
    ds_read_b64 v[154:155], v10 offset:3272
    v_mfma_f32_16x16x32_bf16 v[204:207], v[76:79], v[96:99], v[204:207]
    ds_read_b64 v[156:157], v10 offset:3776
    v_mfma_f32_16x16x32_bf16 v[208:211], v[76:79], v[100:103], v[208:211]
    ds_read_b128 v[188:191], v11 offset:192
    v_mfma_f32_16x16x32_bf16 v[212:215], v[76:79], v[104:107], v[212:215]
    ds_read_b64 v[158:159], v10 offset:3784
    v_mfma_f32_16x16x32_bf16 v[216:219], v[76:79], v[108:111], v[216:219]
    v_mfma_f32_16x16x32_bf16 v[220:223], v[76:79], v[112:115], v[220:223]
    v_mfma_f32_16x16x32_bf16 v[208:211], v[80:83], v[96:99], v[208:211]
    v_mfma_f32_16x16x32_bf16 v[212:215], v[80:83], v[100:103], v[212:215]
    v_mfma_f32_16x16x32_bf16 v[216:219], v[80:83], v[104:107], v[216:219]
    v_mfma_f32_16x16x32_bf16 v[220:223], v[80:83], v[108:111], v[220:223]
    v_mfma_f32_16x16x32_bf16 v[212:215], v[84:87], v[96:99], v[212:215]
    v_mfma_f32_16x16x32_bf16 v[216:219], v[84:87], v[100:103], v[216:219]
    v_mfma_f32_16x16x32_bf16 v[220:223], v[84:87], v[104:107], v[220:223]
    v_mfma_f32_16x16x32_bf16 v[216:219], v[88:91], v[96:99], v[216:219]
    v_mfma_f32_16x16x32_bf16 v[220:223], v[88:91], v[100:103], v[220:223]
    v_mfma_f32_16x16x32_bf16 v[220:223], v[92:95], v[96:99], v[220:223]
    s_waitcnt lgkmcnt(0)
    v_mfma_f32_16x16x32_bf16 v[192:195], v[128:131], v[160:163], v[192:195]
    ds_read_b64 v[64:65], v10 offset:256
    v_mfma_f32_16x16x32_bf16 v[196:199], v[128:131], v[164:167], v[196:199]
    ds_read_b128 v[96:99], v11 offset:3840
    v_mfma_f32_16x16x32_bf16 v[200:203], v[128:131], v[168:171], v[200:203]
    ds_read_b64 v[66:67], v10 offset:264
    v_mfma_f32_16x16x32_bf16 v[204:207], v[128:131], v[172:175], v[204:207]
    ds_read_b64 v[68:69], v10 offset:768
    v_mfma_f32_16x16x32_bf16 v[208:211], v[128:131], v[176:179], v[208:211]
    ds_read_b128 v[100:103], v11 offset:3328
    v_mfma_f32_16x16x32_bf16 v[212:215], v[128:131], v[180:183], v[212:215]
    ds_read_b64 v[70:71], v10 offset:776
    v_mfma_f32_16x16x32_bf16 v[216:219], v[128:131], v[184:187], v[216:219]
    ds_read_b64 v[72:73], v10 offset:1280
    v_mfma_f32_16x16x32_bf16 v[220:223], v[128:131], v[188:191], v[220:223]
    ds_read_b128 v[104:107], v11 offset:2816
    v_mfma_f32_16x16x32_bf16 v[196:199], v[132:135], v[160:163], v[196:199]
    ds_read_b64 v[74:75], v10 offset:1288
    v_mfma_f32_16x16x32_bf16 v[200:203], v[132:135], v[164:167], v[200:203]
    ds_read_b64 v[76:77], v10 offset:1792
    v_mfma_f32_16x16x32_bf16 v[204:207], v[132:135], v[168:171], v[204:207]
    ds_read_b128 v[108:111], v11 offset:2304
    v_mfma_f32_16x16x32_bf16 v[208:211], v[132:135], v[172:175], v[208:211]
    ds_read_b64 v[78:79], v10 offset:1800
    v_mfma_f32_16x16x32_bf16 v[212:215], v[132:135], v[176:179], v[212:215]
    ds_read_b64 v[80:81], v10 offset:2304
    v_mfma_f32_16x16x32_bf16 v[216:219], v[132:135], v[180:183], v[216:219]
    ds_read_b128 v[112:115], v11 offset:1792
    v_mfma_f32_16x16x32_bf16 v[220:223], v[132:135], v[184:187], v[220:223]
    ds_read_b64 v[82:83], v10 offset:2312
    v_mfma_f32_16x16x32_bf16 v[200:203], v[136:139], v[160:163], v[200:203]
    ds_read_b64 v[84:85], v10 offset:2816
    v_mfma_f32_16x16x32_bf16 v[204:207], v[136:139], v[164:167], v[204:207]
    ds_read_b128 v[116:119], v11 offset:1280
    v_mfma_f32_16x16x32_bf16 v[208:211], v[136:139], v[168:171], v[208:211]
    ds_read_b64 v[86:87], v10 offset:2824
    v_mfma_f32_16x16x32_bf16 v[212:215], v[136:139], v[172:175], v[212:215]
    ds_read_b64 v[88:89], v10 offset:3328
    v_mfma_f32_16x16x32_bf16 v[216:219], v[136:139], v[176:179], v[216:219]
    ds_read_b128 v[120:123], v11 offset:768
    v_mfma_f32_16x16x32_bf16 v[220:223], v[136:139], v[180:183], v[220:223]
    ds_read_b64 v[90:91], v10 offset:3336
    v_mfma_f32_16x16x32_bf16 v[204:207], v[140:143], v[160:163], v[204:207]
    ds_read_b64 v[92:93], v10 offset:3840
    v_mfma_f32_16x16x32_bf16 v[208:211], v[140:143], v[164:167], v[208:211]
    ds_read_b128 v[124:127], v11 offset:256
    v_mfma_f32_16x16x32_bf16 v[212:215], v[140:143], v[168:171], v[212:215]
    ds_read_b64 v[94:95], v10 offset:3848
    v_mfma_f32_16x16x32_bf16 v[216:219], v[140:143], v[172:175], v[216:219]
    v_mfma_f32_16x16x32_bf16 v[220:223], v[140:143], v[176:179], v[220:223]
    v_mfma_f32_16x16x32_bf16 v[208:211], v[144:147], v[160:163], v[208:211]
    v_mfma_f32_16x16x32_bf16 v[212:215], v[144:147], v[164:167], v[212:215]
    v_mfma_f32_16x16x32_bf16 v[216:219], v[144:147], v[168:171], v[216:219]
    v_mfma_f32_16x16x32_bf16 v[220:223], v[144:147], v[172:175], v[220:223]
    v_mfma_f32_16x16x32_bf16 v[212:215], v[148:151], v[160:163], v[212:215]
    v_mfma_f32_16x16x32_bf16 v[216:219], v[148:151], v[164:167], v[216:219]
    v_mfma_f32_16x16x32_bf16 v[220:223], v[148:151], v[168:171], v[220:223]
    v_mfma_f32_16x16x32_bf16 v[216:219], v[152:155], v[160:163], v[216:219]
    v_mfma_f32_16x16x32_bf16 v[220:223], v[152:155], v[164:167], v[220:223]
    v_mfma_f32_16x16x32_bf16 v[220:223], v[156:159], v[160:163], v[220:223]
    s_waitcnt lgkmcnt(0)
    v_mfma_f32_16x16x32_bf16 v[192:195], v[64:67], v[96:99], v[192:195]
    ds_read_b64 v[128:129], v10 offset:320
    v_mfma_f32_16x16x32_bf16 v[196:199], v[64:67], v[100:103], v[196:199]
    ds_read_b128 v[160:163], v11 offset:3904
    v_mfma_f32_16x16x32_bf16 v[200:203], v[64:67], v[104:107], v[200:203]
    ds_read_b64 v[130:131], v10 offset:328
    v_mfma_f32_16x16x32_bf16 v[204:207], v[64:67], v[108:111], v[204:207]
    ds_read_b64 v[132:133], v10 offset:832
    v_mfma_f32_16x16x32_bf16 v[208:211], v[64:67], v[112:115], v[208:211]
    ds_read_b128 v[164:167], v11 offset:3392
    v_mfma_f32_16x16x32_bf16 v[212:215], v[64:67], v[116:119], v[212:215]
    ds_read_b64 v[134:135], v10 offset:840
    v_mfma_f32_16x16x32_bf16 v[216:219], v[64:67], v[120:123], v[216:219]
    ds_read_b64 v[136:137], v10 offset:1344
    v_mfma_f32_16x16x32_bf16 v[220:223], v[64:67], v[124:127], v[220:223]
    ds_read_b128 v[168:171], v11 offset:2880
    v_mfma_f32_16x16x32_bf16 v[196:199], v[68:71], v[96:99], v[196:199]
    ds_read_b64 v[138:139], v10 offset:1352
    v_mfma_f32_16x16x32_bf16 v[200:203], v[68:71], v[100:103], v[200:203]
    ds_read_b64 v[140:141], v10 offset:1856
    v_mfma_f32_16x16x32_bf16 v[204:207], v[68:71], v[104:107], v[204:207]
    ds_read_b128 v[172:175], v11 offset:2368
    v_mfma_f32_16x16x32_bf16 v[208:211], v[68:71], v[108:111], v[208:211]
    ds_read_b64 v[142:143], v10 offset:1864
    v_mfma_f32_16x16x32_bf16 v[212:215], v[68:71], v[112:115], v[212:215]
    ds_read_b64 v[144:145], v10 offset:2368
    v_mfma_f32_16x16x32_bf16 v[216:219], v[68:71], v[116:119], v[216:219]
    ds_read_b128 v[176:179], v11 offset:1856
    v_mfma_f32_16x16x32_bf16 v[220:223], v[68:71], v[120:123], v[220:223]
    ds_read_b64 v[146:147], v10 offset:2376
    v_mfma_f32_16x16x32_bf16 v[200:203], v[72:75], v[96:99], v[200:203]
    ds_read_b64 v[148:149], v10 offset:2880
    v_mfma_f32_16x16x32_bf16 v[204:207], v[72:75], v[100:103], v[204:207]
    ds_read_b128 v[180:183], v11 offset:1344
    v_mfma_f32_16x16x32_bf16 v[208:211], v[72:75], v[104:107], v[208:211]
    ds_read_b64 v[150:151], v10 offset:2888
    v_mfma_f32_16x16x32_bf16 v[212:215], v[72:75], v[108:111], v[212:215]
    ds_read_b64 v[152:153], v10 offset:3392
    v_mfma_f32_16x16x32_bf16 v[216:219], v[72:75], v[112:115], v[216:219]
    ds_read_b128 v[184:187], v11 offset:832
    v_mfma_f32_16x16x32_bf16 v[220:223], v[72:75], v[116:119], v[220:223]
    ds_read_b64 v[154:155], v10 offset:3400
    v_mfma_f32_16x16x32_bf16 v[204:207], v[76:79], v[96:99], v[204:207]
    ds_read_b64 v[156:157], v10 offset:3904
    v_mfma_f32_16x16x32_bf16 v[208:211], v[76:79], v[100:103], v[208:211]
    ds_read_b128 v[188:191], v11 offset:320
    v_mfma_f32_16x16x32_bf16 v[212:215], v[76:79], v[104:107], v[212:215]
    ds_read_b64 v[158:159], v10 offset:3912
    v_mfma_f32_16x16x32_bf16 v[216:219], v[76:79], v[108:111], v[216:219]
    v_mfma_f32_16x16x32_bf16 v[220:223], v[76:79], v[112:115], v[220:223]
    v_mfma_f32_16x16x32_bf16 v[208:211], v[80:83], v[96:99], v[208:211]
    v_mfma_f32_16x16x32_bf16 v[212:215], v[80:83], v[100:103], v[212:215]
    v_mfma_f32_16x16x32_bf16 v[216:219], v[80:83], v[104:107], v[216:219]
    v_mfma_f32_16x16x32_bf16 v[220:223], v[80:83], v[108:111], v[220:223]
    v_mfma_f32_16x16x32_bf16 v[212:215], v[84:87], v[96:99], v[212:215]
    v_mfma_f32_16x16x32_bf16 v[216:219], v[84:87], v[100:103], v[216:219]
    v_mfma_f32_16x16x32_bf16 v[220:223], v[84:87], v[104:107], v[220:223]
    v_mfma_f32_16x16x32_bf16 v[216:219], v[88:91], v[96:99], v[216:219]
    v_mfma_f32_16x16x32_bf16 v[220:223], v[88:91], v[100:103], v[220:223]
    v_mfma_f32_16x16x32_bf16 v[220:223], v[92:95], v[96:99], v[220:223]
    s_waitcnt lgkmcnt(0)
    v_mfma_f32_16x16x32_bf16 v[192:195], v[128:131], v[160:163], v[192:195]
    ds_read_b64 v[64:65], v10 offset:384
    v_mfma_f32_16x16x32_bf16 v[196:199], v[128:131], v[164:167], v[196:199]
    ds_read_b128 v[96:99], v11 offset:3968
    v_mfma_f32_16x16x32_bf16 v[200:203], v[128:131], v[168:171], v[200:203]
    ds_read_b64 v[66:67], v10 offset:392
    v_mfma_f32_16x16x32_bf16 v[204:207], v[128:131], v[172:175], v[204:207]
    ds_read_b64 v[68:69], v10 offset:896
    v_mfma_f32_16x16x32_bf16 v[208:211], v[128:131], v[176:179], v[208:211]
    ds_read_b128 v[100:103], v11 offset:3456
    v_mfma_f32_16x16x32_bf16 v[212:215], v[128:131], v[180:183], v[212:215]
    ds_read_b64 v[70:71], v10 offset:904
    v_mfma_f32_16x16x32_bf16 v[216:219], v[128:131], v[184:187], v[216:219]
    ds_read_b64 v[72:73], v10 offset:1408
    v_mfma_f32_16x16x32_bf16 v[220:223], v[128:131], v[188:191], v[220:223]
    ds_read_b128 v[104:107], v11 offset:2944
    v_mfma_f32_16x16x32_bf16 v[196:199], v[132:135], v[160:163], v[196:199]
    ds_read_b64 v[74:75], v10 offset:1416
    v_mfma_f32_16x16x32_bf16 v[200:203], v[132:135], v[164:167], v[200:203]
    ds_read_b64 v[76:77], v10 offset:1920
    v_mfma_f32_16x16x32_bf16 v[204:207], v[132:135], v[168:171], v[204:207]
    ds_read_b128 v[108:111], v11 offset:2432
    v_mfma_f32_16x16x32_bf16 v[208:211], v[132:135], v[172:175], v[208:211]
    ds_read_b64 v[78:79], v10 offset:1928
    v_mfma_f32_16x16x32_bf16 v[212:215], v[132:135], v[176:179], v[212:215]
    ds_read_b64 v[80:81], v10 offset:2432
    v_mfma_f32_16x16x32_bf16 v[216:219], v[132:135], v[180:183], v[216:219]
    ds_read_b128 v[112:115], v11 offset:1920
    v_mfma_f32_16x16x32_bf16 v[220:223], v[132:135], v[184:187], v[220:223]
    ds_read_b64 v[82:83], v10 offset:2440
    v_mfma_f32_16x16x32_bf16 v[200:203], v[136:139], v[160:163], v[200:203]
    ds_read_b64 v[84:85], v10 offset:2944
    v_mfma_f32_16x16x32_bf16 v[204:207], v[136:139], v[164:167], v[204:207]
    ds_read_b128 v[116:119], v11 offset:1408
    v_mfma_f32_16x16x32_bf16 v[208:211], v[136:139], v[168:171], v[208:211]
    ds_read_b64 v[86:87], v10 offset:2952
    v_mfma_f32_16x16x32_bf16 v[212:215], v[136:139], v[172:175], v[212:215]
    ds_read_b64 v[88:89], v10 offset:3456
    v_mfma_f32_16x16x32_bf16 v[216:219], v[136:139], v[176:179], v[216:219]
    ds_read_b128 v[120:123], v11 offset:896
    v_mfma_f32_16x16x32_bf16 v[220:223], v[136:139], v[180:183], v[220:223]
    ds_read_b64 v[90:91], v10 offset:3464
    v_mfma_f32_16x16x32_bf16 v[204:207], v[140:143], v[160:163], v[204:207]
    ds_read_b64 v[92:93], v10 offset:3968
    v_mfma_f32_16x16x32_bf16 v[208:211], v[140:143], v[164:167], v[208:211]
    ds_read_b128 v[124:127], v11 offset:384
    v_mfma_f32_16x16x32_bf16 v[212:215], v[140:143], v[168:171], v[212:215]
    ds_read_b64 v[94:95], v10 offset:3976
    v_mfma_f32_16x16x32_bf16 v[216:219], v[140:143], v[172:175], v[216:219]
    v_mfma_f32_16x16x32_bf16 v[220:223], v[140:143], v[176:179], v[220:223]
    v_mfma_f32_16x16x32_bf16 v[208:211], v[144:147], v[160:163], v[208:211]
    v_mfma_f32_16x16x32_bf16 v[212:215], v[144:147], v[164:167], v[212:215]
    v_mfma_f32_16x16x32_bf16 v[216:219], v[144:147], v[168:171], v[216:219]
    v_mfma_f32_16x16x32_bf16 v[220:223], v[144:147], v[172:175], v[220:223]
    v_mfma_f32_16x16x32_bf16 v[212:215], v[148:151], v[160:163], v[212:215]
    v_mfma_f32_16x16x32_bf16 v[216:219], v[148:151], v[164:167], v[216:219]
    v_mfma_f32_16x16x32_bf16 v[220:223], v[148:151], v[168:171], v[220:223]
    v_mfma_f32_16x16x32_bf16 v[216:219], v[152:155], v[160:163], v[216:219]
    v_mfma_f32_16x16x32_bf16 v[220:223], v[152:155], v[164:167], v[220:223]
    v_mfma_f32_16x16x32_bf16 v[220:223], v[156:159], v[160:163], v[220:223]
    s_waitcnt lgkmcnt(0)
    v_mfma_f32_16x16x32_bf16 v[192:195], v[64:67], v[96:99], v[192:195]
    ds_read_b64 v[128:129], v10 offset:448
    v_mfma_f32_16x16x32_bf16 v[196:199], v[64:67], v[100:103], v[196:199]
    ds_read_b128 v[160:163], v11 offset:4032
    v_mfma_f32_16x16x32_bf16 v[200:203], v[64:67], v[104:107], v[200:203]
    ds_read_b64 v[130:131], v10 offset:456
    v_mfma_f32_16x16x32_bf16 v[204:207], v[64:67], v[108:111], v[204:207]
    ds_read_b64 v[132:133], v10 offset:960
    v_mfma_f32_16x16x32_bf16 v[208:211], v[64:67], v[112:115], v[208:211]
    ds_read_b128 v[164:167], v11 offset:3520
    v_mfma_f32_16x16x32_bf16 v[212:215], v[64:67], v[116:119], v[212:215]
    ds_read_b64 v[134:135], v10 offset:968
    v_mfma_f32_16x16x32_bf16 v[216:219], v[64:67], v[120:123], v[216:219]
    ds_read_b64 v[136:137], v10 offset:1472
    v_mfma_f32_16x16x32_bf16 v[220:223], v[64:67], v[124:127], v[220:223]
    ds_read_b128 v[168:171], v11 offset:3008
    v_mfma_f32_16x16x32_bf16 v[196:199], v[68:71], v[96:99], v[196:199]
    ds_read_b64 v[138:139], v10 offset:1480
    v_mfma_f32_16x16x32_bf16 v[200:203], v[68:71], v[100:103], v[200:203]
    ds_read_b64 v[140:141], v10 offset:1984
    v_mfma_f32_16x16x32_bf16 v[204:207], v[68:71], v[104:107], v[204:207]
    ds_read_b128 v[172:175], v11 offset:2496
    v_mfma_f32_16x16x32_bf16 v[208:211], v[68:71], v[108:111], v[208:211]
    ds_read_b64 v[142:143], v10 offset:1992
    v_mfma_f32_16x16x32_bf16 v[212:215], v[68:71], v[112:115], v[212:215]
    ds_read_b64 v[144:145], v10 offset:2496
    v_mfma_f32_16x16x32_bf16 v[216:219], v[68:71], v[116:119], v[216:219]
    ds_read_b128 v[176:179], v11 offset:1984
    v_mfma_f32_16x16x32_bf16 v[220:223], v[68:71], v[120:123], v[220:223]
    ds_read_b64 v[146:147], v10 offset:2504
    v_mfma_f32_16x16x32_bf16 v[200:203], v[72:75], v[96:99], v[200:203]
    ds_read_b64 v[148:149], v10 offset:3008
    v_mfma_f32_16x16x32_bf16 v[204:207], v[72:75], v[100:103], v[204:207]
    ds_read_b128 v[180:183], v11 offset:1472
    v_mfma_f32_16x16x32_bf16 v[208:211], v[72:75], v[104:107], v[208:211]
    ds_read_b64 v[150:151], v10 offset:3016
    v_mfma_f32_16x16x32_bf16 v[212:215], v[72:75], v[108:111], v[212:215]
    ds_read_b64 v[152:153], v10 offset:3520
    v_mfma_f32_16x16x32_bf16 v[216:219], v[72:75], v[112:115], v[216:219]
    ds_read_b128 v[184:187], v11 offset:960
    v_mfma_f32_16x16x32_bf16 v[220:223], v[72:75], v[116:119], v[220:223]
    ds_read_b64 v[154:155], v10 offset:3528
    v_mfma_f32_16x16x32_bf16 v[204:207], v[76:79], v[96:99], v[204:207]
    ds_read_b64 v[156:157], v10 offset:4032
    v_mfma_f32_16x16x32_bf16 v[208:211], v[76:79], v[100:103], v[208:211]
    ds_read_b128 v[188:191], v11 offset:448
    v_mfma_f32_16x16x32_bf16 v[212:215], v[76:79], v[104:107], v[212:215]
    ds_read_b64 v[158:159], v10 offset:4040
    v_mfma_f32_16x16x32_bf16 v[216:219], v[76:79], v[108:111], v[216:219]
    v_mfma_f32_16x16x32_bf16 v[220:223], v[76:79], v[112:115], v[220:223]
    v_mfma_f32_16x16x32_bf16 v[208:211], v[80:83], v[96:99], v[208:211]
    v_mfma_f32_16x16x32_bf16 v[212:215], v[80:83], v[100:103], v[212:215]
    v_mfma_f32_16x16x32_bf16 v[216:219], v[80:83], v[104:107], v[216:219]
    v_mfma_f32_16x16x32_bf16 v[220:223], v[80:83], v[108:111], v[220:223]
    v_mfma_f32_16x16x32_bf16 v[212:215], v[84:87], v[96:99], v[212:215]
    v_mfma_f32_16x16x32_bf16 v[216:219], v[84:87], v[100:103], v[216:219]
    v_mfma_f32_16x16x32_bf16 v[220:223], v[84:87], v[104:107], v[220:223]
    v_mfma_f32_16x16x32_bf16 v[216:219], v[88:91], v[96:99], v[216:219]
    v_mfma_f32_16x16x32_bf16 v[220:223], v[88:91], v[100:103], v[220:223]
    v_mfma_f32_16x16x32_bf16 v[220:223], v[92:95], v[96:99], v[220:223]
    s_waitcnt lgkmcnt(0)
    v_mfma_f32_16x16x32_bf16 v[192:195], v[128:131], v[160:163], v[192:195]
    v_mfma_f32_16x16x32_bf16 v[196:199], v[128:131], v[164:167], v[196:199]
    v_mfma_f32_16x16x32_bf16 v[200:203], v[128:131], v[168:171], v[200:203]
    v_mfma_f32_16x16x32_bf16 v[204:207], v[128:131], v[172:175], v[204:207]
    v_mfma_f32_16x16x32_bf16 v[208:211], v[128:131], v[176:179], v[208:211]
    v_mfma_f32_16x16x32_bf16 v[212:215], v[128:131], v[180:183], v[212:215]
    v_mfma_f32_16x16x32_bf16 v[216:219], v[128:131], v[184:187], v[216:219]
    v_mfma_f32_16x16x32_bf16 v[220:223], v[128:131], v[188:191], v[220:223]
    v_mfma_f32_16x16x32_bf16 v[196:199], v[132:135], v[160:163], v[196:199]
    v_mfma_f32_16x16x32_bf16 v[200:203], v[132:135], v[164:167], v[200:203]
    v_mfma_f32_16x16x32_bf16 v[204:207], v[132:135], v[168:171], v[204:207]
    v_mfma_f32_16x16x32_bf16 v[208:211], v[132:135], v[172:175], v[208:211]
    v_mfma_f32_16x16x32_bf16 v[212:215], v[132:135], v[176:179], v[212:215]
    v_mfma_f32_16x16x32_bf16 v[216:219], v[132:135], v[180:183], v[216:219]
    v_mfma_f32_16x16x32_bf16 v[220:223], v[132:135], v[184:187], v[220:223]
    v_mfma_f32_16x16x32_bf16 v[200:203], v[136:139], v[160:163], v[200:203]
    v_mfma_f32_16x16x32_bf16 v[204:207], v[136:139], v[164:167], v[204:207]
    v_mfma_f32_16x16x32_bf16 v[208:211], v[136:139], v[168:171], v[208:211]
    v_mfma_f32_16x16x32_bf16 v[212:215], v[136:139], v[172:175], v[212:215]
    v_mfma_f32_16x16x32_bf16 v[216:219], v[136:139], v[176:179], v[216:219]
    v_mfma_f32_16x16x32_bf16 v[220:223], v[136:139], v[180:183], v[220:223]
    v_mfma_f32_16x16x32_bf16 v[204:207], v[140:143], v[160:163], v[204:207]
    v_mfma_f32_16x16x32_bf16 v[208:211], v[140:143], v[164:167], v[208:211]
    v_mfma_f32_16x16x32_bf16 v[212:215], v[140:143], v[168:171], v[212:215]
    v_mfma_f32_16x16x32_bf16 v[216:219], v[140:143], v[172:175], v[216:219]
    v_mfma_f32_16x16x32_bf16 v[220:223], v[140:143], v[176:179], v[220:223]
    v_mfma_f32_16x16x32_bf16 v[208:211], v[144:147], v[160:163], v[208:211]
    v_mfma_f32_16x16x32_bf16 v[212:215], v[144:147], v[164:167], v[212:215]
    v_mfma_f32_16x16x32_bf16 v[216:219], v[144:147], v[168:171], v[216:219]
    v_mfma_f32_16x16x32_bf16 v[220:223], v[144:147], v[172:175], v[220:223]
    v_mfma_f32_16x16x32_bf16 v[212:215], v[148:151], v[160:163], v[212:215]
    v_mfma_f32_16x16x32_bf16 v[216:219], v[148:151], v[164:167], v[216:219]
    v_mfma_f32_16x16x32_bf16 v[220:223], v[148:151], v[168:171], v[220:223]
    v_mfma_f32_16x16x32_bf16 v[216:219], v[152:155], v[160:163], v[216:219]
    v_mfma_f32_16x16x32_bf16 v[220:223], v[152:155], v[164:167], v[220:223]
    v_mfma_f32_16x16x32_bf16 v[220:223], v[156:159], v[160:163], v[220:223]
    ds_read_b64 v[64:65], v13 offset:3584
    ds_read_b64 v[66:67], v13 offset:3072
    ds_read_b64 v[68:69], v13 offset:2560
    ds_read_b64 v[70:71], v13 offset:2048
    ds_read_b64 v[72:73], v13 offset:1536
    ds_read_b64 v[74:75], v13 offset:1024
    ds_read_b64 v[76:77], v13 offset:512
    ds_read_b64 v[78:79], v13 offset:0
    v_lshlrev_b32 v4, 16, v4
    v_mov_b32 v5, v4
    s_nop 7
    s_waitcnt lgkmcnt(0)
    v_and_b32 v96, 0xffff0000, v65
    v_lshlrev_b32 v97, 16, v65
    v_and_b32 v98, 0xffff0000, v64
    v_lshlrev_b32 v99, 16, v64
    v_mul_f32 v96, v96, v4
    v_mul_f32 v97, v97, v4
    v_mul_f32 v98, v98, v4
    v_mul_f32 v99, v99, v4
    v_cvt_pk_bf16_f32 v96, 0, v96
    v_cvt_pk_bf16_f32 v97, 0, v97
    v_cvt_pk_bf16_f32 v98, 0, v98
    v_cvt_pk_bf16_f32 v99, 0, v99
    v_cvt_pk_bf16_f32 v192, 0, v192
    v_cvt_pk_bf16_f32 v193, 0, v193
    v_cvt_pk_bf16_f32 v194, 0, v194
    v_cvt_pk_bf16_f32 v195, 0, v195
    v_add_f32 v96, v96, v192
    v_add_f32 v97, v97, v193
    v_add_f32 v98, v98, v194
    v_add_f32 v99, v99, v195
    v_cvt_pk_bf16_f32 v112, v96, v97
    v_cvt_pk_bf16_f32 v113, v98, v99
    v_and_b32 v96, 0xffff0000, v67
    v_lshlrev_b32 v97, 16, v67
    v_and_b32 v98, 0xffff0000, v66
    v_lshlrev_b32 v99, 16, v66
    v_mul_f32 v96, v96, v4
    v_mul_f32 v97, v97, v4
    v_mul_f32 v98, v98, v4
    v_mul_f32 v99, v99, v4
    v_cvt_pk_bf16_f32 v96, 0, v96
    v_cvt_pk_bf16_f32 v97, 0, v97
    v_cvt_pk_bf16_f32 v98, 0, v98
    v_cvt_pk_bf16_f32 v99, 0, v99
    v_cvt_pk_bf16_f32 v196, 0, v196
    v_cvt_pk_bf16_f32 v197, 0, v197
    v_cvt_pk_bf16_f32 v198, 0, v198
    v_cvt_pk_bf16_f32 v199, 0, v199
    v_add_f32 v96, v96, v196
    v_add_f32 v97, v97, v197
    v_add_f32 v98, v98, v198
    v_add_f32 v99, v99, v199
    v_cvt_pk_bf16_f32 v114, v96, v97
    v_cvt_pk_bf16_f32 v115, v98, v99
    s_nop 1
    v_permlane16_swap_b32 v112, v114
    v_permlane16_swap_b32 v113, v115
    buffer_store_dwordx4 v[112:115], v12, s[12:15], s23 offen offset:0 sc1
    v_and_b32 v96, 0xffff0000, v69
    v_lshlrev_b32 v97, 16, v69
    v_and_b32 v98, 0xffff0000, v68
    v_lshlrev_b32 v99, 16, v68
    v_mul_f32 v96, v96, v4
    v_mul_f32 v97, v97, v4
    v_mul_f32 v98, v98, v4
    v_mul_f32 v99, v99, v4
    v_cvt_pk_bf16_f32 v96, 0, v96
    v_cvt_pk_bf16_f32 v97, 0, v97
    v_cvt_pk_bf16_f32 v98, 0, v98
    v_cvt_pk_bf16_f32 v99, 0, v99
    v_cvt_pk_bf16_f32 v200, 0, v200
    v_cvt_pk_bf16_f32 v201, 0, v201
    v_cvt_pk_bf16_f32 v202, 0, v202
    v_cvt_pk_bf16_f32 v203, 0, v203
    v_add_f32 v96, v96, v200
    v_add_f32 v97, v97, v201
    v_add_f32 v98, v98, v202
    v_add_f32 v99, v99, v203
    v_cvt_pk_bf16_f32 v116, v96, v97
    v_cvt_pk_bf16_f32 v117, v98, v99
    v_and_b32 v96, 0xffff0000, v71
    v_lshlrev_b32 v97, 16, v71
    v_and_b32 v98, 0xffff0000, v70
    v_lshlrev_b32 v99, 16, v70
    v_mul_f32 v96, v96, v4
    v_mul_f32 v97, v97, v4
    v_mul_f32 v98, v98, v4
    v_mul_f32 v99, v99, v4
    v_cvt_pk_bf16_f32 v96, 0, v96
    v_cvt_pk_bf16_f32 v97, 0, v97
    v_cvt_pk_bf16_f32 v98, 0, v98
    v_cvt_pk_bf16_f32 v99, 0, v99
    v_cvt_pk_bf16_f32 v204, 0, v204
    v_cvt_pk_bf16_f32 v205, 0, v205
    v_cvt_pk_bf16_f32 v206, 0, v206
    v_cvt_pk_bf16_f32 v207, 0, v207
    v_add_f32 v96, v96, v204
    v_add_f32 v97, v97, v205
    v_add_f32 v98, v98, v206
    v_add_f32 v99, v99, v207
    v_cvt_pk_bf16_f32 v118, v96, v97
    v_cvt_pk_bf16_f32 v119, v98, v99
    s_nop 1
    v_permlane16_swap_b32 v116, v118
    v_permlane16_swap_b32 v117, v119
    buffer_store_dwordx4 v[116:119], v12, s[12:15], s23 offen offset:1024 sc1
    v_and_b32 v96, 0xffff0000, v73
    v_lshlrev_b32 v97, 16, v73
    v_and_b32 v98, 0xffff0000, v72
    v_lshlrev_b32 v99, 16, v72
    v_mul_f32 v96, v96, v4
    v_mul_f32 v97, v97, v4
    v_mul_f32 v98, v98, v4
    v_mul_f32 v99, v99, v4
    v_cvt_pk_bf16_f32 v96, 0, v96
    v_cvt_pk_bf16_f32 v97, 0, v97
    v_cvt_pk_bf16_f32 v98, 0, v98
    v_cvt_pk_bf16_f32 v99, 0, v99
    v_cvt_pk_bf16_f32 v208, 0, v208
    v_cvt_pk_bf16_f32 v209, 0, v209
    v_cvt_pk_bf16_f32 v210, 0, v210
    v_cvt_pk_bf16_f32 v211, 0, v211
    v_add_f32 v96, v96, v208
    v_add_f32 v97, v97, v209
    v_add_f32 v98, v98, v210
    v_add_f32 v99, v99, v211
    v_cvt_pk_bf16_f32 v120, v96, v97
    v_cvt_pk_bf16_f32 v121, v98, v99
    v_and_b32 v96, 0xffff0000, v75
    v_lshlrev_b32 v97, 16, v75
    v_and_b32 v98, 0xffff0000, v74
    v_lshlrev_b32 v99, 16, v74
    v_mul_f32 v96, v96, v4
    v_mul_f32 v97, v97, v4
    v_mul_f32 v98, v98, v4
    v_mul_f32 v99, v99, v4
    v_cvt_pk_bf16_f32 v96, 0, v96
    v_cvt_pk_bf16_f32 v97, 0, v97
    v_cvt_pk_bf16_f32 v98, 0, v98
    v_cvt_pk_bf16_f32 v99, 0, v99
    v_cvt_pk_bf16_f32 v212, 0, v212
    v_cvt_pk_bf16_f32 v213, 0, v213
    v_cvt_pk_bf16_f32 v214, 0, v214
    v_cvt_pk_bf16_f32 v215, 0, v215
    v_add_f32 v96, v96, v212
    v_add_f32 v97, v97, v213
    v_add_f32 v98, v98, v214
    v_add_f32 v99, v99, v215
    v_cvt_pk_bf16_f32 v122, v96, v97
    v_cvt_pk_bf16_f32 v123, v98, v99
    s_nop 1
    v_permlane16_swap_b32 v120, v122
    v_permlane16_swap_b32 v121, v123
    buffer_store_dwordx4 v[120:123], v12, s[12:15], s23 offen offset:2048 sc1
    v_and_b32 v96, 0xffff0000, v77
    v_lshlrev_b32 v97, 16, v77
    v_and_b32 v98, 0xffff0000, v76
    v_lshlrev_b32 v99, 16, v76
    v_mul_f32 v96, v96, v4
    v_mul_f32 v97, v97, v4
    v_mul_f32 v98, v98, v4
    v_mul_f32 v99, v99, v4
    v_cvt_pk_bf16_f32 v96, 0, v96
    v_cvt_pk_bf16_f32 v97, 0, v97
    v_cvt_pk_bf16_f32 v98, 0, v98
    v_cvt_pk_bf16_f32 v99, 0, v99
    v_cvt_pk_bf16_f32 v216, 0, v216
    v_cvt_pk_bf16_f32 v217, 0, v217
    v_cvt_pk_bf16_f32 v218, 0, v218
    v_cvt_pk_bf16_f32 v219, 0, v219
    v_add_f32 v96, v96, v216
    v_add_f32 v97, v97, v217
    v_add_f32 v98, v98, v218
    v_add_f32 v99, v99, v219
    v_cvt_pk_bf16_f32 v124, v96, v97
    v_cvt_pk_bf16_f32 v125, v98, v99
    v_and_b32 v96, 0xffff0000, v79
    v_lshlrev_b32 v97, 16, v79
    v_and_b32 v98, 0xffff0000, v78
    v_lshlrev_b32 v99, 16, v78
    v_mul_f32 v96, v96, v4
    v_mul_f32 v97, v97, v4
    v_mul_f32 v98, v98, v4
    v_mul_f32 v99, v99, v4
    v_cvt_pk_bf16_f32 v96, 0, v96
    v_cvt_pk_bf16_f32 v97, 0, v97
    v_cvt_pk_bf16_f32 v98, 0, v98
    v_cvt_pk_bf16_f32 v99, 0, v99
    v_cvt_pk_bf16_f32 v220, 0, v220
    v_cvt_pk_bf16_f32 v221, 0, v221
    v_cvt_pk_bf16_f32 v222, 0, v222
    v_cvt_pk_bf16_f32 v223, 0, v223
    v_add_f32 v96, v96, v220
    v_add_f32 v97, v97, v221
    v_add_f32 v98, v98, v222
    v_add_f32 v99, v99, v223
    v_cvt_pk_bf16_f32 v126, v96, v97
    v_cvt_pk_bf16_f32 v127, v98, v99
    s_nop 1
    v_permlane16_swap_b32 v124, v126
    v_permlane16_swap_b32 v125, v127
    buffer_store_dwordx4 v[124:127], v12, s[12:15], s23 offen offset:3072 sc1
    s_waitcnt vmcnt(0)
    v_mov_b32 v16, 156744
    v_mov_b32 v17, 1
    s_mov_b64 exec, 1
    ds_add_rtn_u32 v17, v16, v17
    s_mov_b64 exec, -1
    s_waitcnt lgkmcnt(0)
    v_readfirstlane_b32 s24, v17
    s_nop 3
    s_cmp_lg_u32 s24, 3
    s_cbranch_scc1 nz_55
    s_mul_hi_u32 s24, s2, 0x0CCCCCCD
    s_mul_i32 s25, s24, 20
    s_sub_u32 s25, s2, s25
    v_and_b32 v16, 63, v0
    v_mov_b32 v17, s24
    v_lshrrev_b32 v18, 3, v16
    v_lshlrev_b32 v18, 1, v18
    v_lshrrev_b32 v19, 2, v17
    v_add_u32 v18, v18, v19
    v_and_b32 v19, 3, v17
    v_lshlrev_b32 v19, 6, v19
    v_add_u32 v18, v18, v19
    v_and_b32 v19, 7, v16
    v_lshl_add_u32 v18, v19, 3, v18
    v_lshlrev_b32 v18, 9, v18
    s_lshl_b32 s25, s25, 2
    s_add_u32 s25, s25, 194688
    v_add_u32 v18, s25, v18
    v_mov_b32 v19, s28
    s_mov_b64 s[48:49], exec
    s_mov_b32 exec_hi, 0
    buffer_store_dword v19, v18, s[40:43], 0 offen sc1
    s_mov_b64 exec, s[48:49]
nz_55:
    s_setprio 0
    s_branch L_convend
L_convdone:
    s_cmp_lg_u32 s2, 191
    s_cbranch_scc1 L_convend
    s_cmp_lg_u32 s29, 7
    s_cbranch_scc1 L_convend
    s_mov_b32 s26, 0
    v_mov_b32 v8, 156736
ldsw_56:
    ds_read_b32 v9, v8
    s_waitcnt lgkmcnt(0)
    v_readfirstlane_b32 s24, v9
    s_nop 3
    s_cmp_lg_u32 s24, 0
    s_cbranch_scc1 ldswd_57
    s_sleep 2
    s_add_u32 s26, s26, 1
    s_cmp_lt_u32 s26, 800000
    s_cbranch_scc1 ldsw_56
    v_mov_b32 v250, 4
    v_mov_b32 v251, 0xdead
    buffer_store_dword v251, v250, s[44:47], 0 offen sc1
ldswd_57:
    v_and_b32 v2, 63, v0
    v_lshlrev_b32 v3, 7, v2
    s_mov_b32 s26, 0
ep_58:
    v_add_u32 v4, 169984, v3
    buffer_load_dword v8, v4, s[40:43], 0 offen sc1
    v_add_u32 v4, 178176, v3
    buffer_load_dword v9, v4, s[40:43], 0 offen sc1
    v_add_u32 v4, 186368, v3
    buffer_load_dword v10, v4, s[40:43], 0 offen sc1
    v_add_u32 v4, 63488, v3
    buffer_load_dword v11, v4, s[40:43], 0 offen sc1
    s_waitcnt vmcnt(0)
    v_mov_b32 v5, 0
    v_xor_b32 v6, s28, v8
    v_or_b32 v5, v5, v6
    v_xor_b32 v6, s28, v9
    v_or_b32 v5, v5, v6
    v_xor_b32 v6, s28, v10
    v_or_b32 v5, v5, v6
    v_xor_b32 v6, s28, v11
    v_or_b32 v5, v5, v6
    v_cmp_ne_u32 vcc, 0, v5
    s_nop 4
    s_cbranch_vccz epd_59
    s_sleep 16
    s_add_u32 s26, s26, 1
    s_cmp_lt_u32 s26, 40000
    s_cbranch_scc1 ep_58
    v_mov_b32 v250, 4
    v_mov_b32 v251, 0xdead
    buffer_store_dword v251, v250, s[44:47], 0 offen sc1
epd_59:
    s_mov_b32 s24, 325632
    v_mov_b32 v4, s28
    v_mov_b32 v5, 0
    s_mov_b64 s[48:49], exec
    s_mov_b64 exec, 1
    buffer_store_dword v4, v5, s[40:43], s24 offen offset:0 sc1
    s_mov_b64 exec, s[48:49]
L_convend:
    s_and_b32 s24, s2, 7
    s_lshr_b32 s25, s2, 3
    s_lshr_b32 s26, s24, 1
    s_lshl_b32 s26, s26, 3
    s_and_b32 s30, s25, 7
    s_add_u32 s30, s26, s30
    s_and_b32 s26, s24, 1
    s_lshl_b32 s26, s26, 2
    s_lshr_b32 s31, s25, 3
    s_add_u32 s31, s26, s31
    s_sub_u32 s27, s29, 4
    s_mov_b64 s[12:13], s[72:73]
    s_and_b32 s13, s13, 0xffff
    s_mov_b32 s14, 2621440
    s_mov_b32 s15, 0x00020000
    s_mov_b64 s[16:17], s[98:99]
    s_add_u32 s16, s16, 10878976
    s_addc_u32 s17, s17, 0
    s_and_b32 s17, s17, 0xffff
    s_mov_b32 s18, 2621440
    s_mov_b32 s19, 0x00020000
    s_mov_b64 s[52:53], s[98:99]
    s_add_u32 s52, s52, 13500416
    s_addc_u32 s53, s53, 0
    s_and_b32 s53, s53, 0xffff
    s_mov_b32 s54, 16384
    s_mov_b32 s55, 0x00020000
    s_mov_b64 s[20:21], s[92:93]
    s_and_b32 s21, s21, 0xffff
    s_mov_b32 s22, 1280
    s_mov_b32 s23, 0x00020000
    v_and_b32 v2, 63, v0
    v_lshlrev_b32 v3, 4, v2
    v_and_b32 v5, 15, v2
    v_lshrrev_b32 v8, 4, v2
    s_lshl_b32 s24, s30, 6
    s_lshl_b32 s25, s27, 4
    s_add_u32 s24, s24, s25
    v_add_u32 v5, s24, v5
    v_lshlrev_b32 v9, 3, v5
    s_movk_i32 s26, 1280
    v_mul_lo_u32 v20, v5, s26
    s_mul_i32 s25, s31, 160
    v_lshlrev_b32 v21, 3, v8
    v_add_u32 v21, s25, v21
    v_add_u32 v20, v20, v21
    s_mov_b32 s26, 0
    v_mov_b32 v24, 156736
ldsw_60:
    ds_read_b32 v25, v24
    s_waitcnt lgkmcnt(0)
    v_readfirstlane_b32 s24, v25
    s_nop 3
    s_cmp_lg_u32 s24, 0
    s_cbranch_scc1 ldswd_61
    s_sleep 2
    s_add_u32 s26, s26, 1
    s_cmp_lt_u32 s26, 800000
    s_cbranch_scc1 ldsw_60
    v_mov_b32 v250, 4
    v_mov_b32 v251, 0xdead
    buffer_store_dword v251, v250, s[44:47], 0 offen sc1
ldswd_61:
    buffer_load_dwordx2 v[104:105], v21, s[20:23], 0 offen offset:96
    buffer_load_dwordx2 v[10:11], v20, s[12:15], 0 offen offset:96
    buffer_load_dwordx2 v[106:107], v21, s[20:23], 0 offen offset:128
    buffer_load_dwordx2 v[12:13], v20, s[12:15], 0 offen offset:128
    s_mul_i32 s24, s31, 80
    s_mul_i32 s25, s27, 20
    s_add_u32 s34, s24, s25
    s_cmp_lg_u32 s29, 4
    s_cbranch_scc1 zo_62
    s_lshl_b32 s35, s2, 9
    s_add_u32 s35, s35, 194688
    s_add_u32 s36, s35, 64
    s_mov_b32 s26, 0
sp_64:
    s_load_dwordx16 s[56:71], s[50:51], s35 glc
    s_waitcnt lgkmcnt(0)
    s_xor_b32 s48, s56, s28
    s_xor_b32 s49, s57, s28
    s_or_b32 s48, s48, s49
    s_xor_b32 s49, s58, s28
    s_or_b32 s48, s48, s49
    s_xor_b32 s49, s59, s28
    s_or_b32 s48, s48, s49
    s_xor_b32 s49, s60, s28
    s_or_b32 s48, s48, s49
    s_xor_b32 s49, s61, s28
    s_or_b32 s48, s48, s49
    s_xor_b32 s49, s62, s28
    s_or_b32 s48, s48, s49
    s_xor_b32 s49, s63, s28
    s_or_b32 s48, s48, s49
    s_xor_b32 s49, s64, s28
    s_or_b32 s48, s48, s49
    s_xor_b32 s49, s65, s28
    s_or_b32 s48, s48, s49
    s_xor_b32 s49, s66, s28
    s_or_b32 s48, s48, s49
    s_xor_b32 s49, s67, s28
    s_or_b32 s48, s48, s49
    s_xor_b32 s49, s68, s28
    s_or_b32 s48, s48, s49
    s_xor_b32 s49, s69, s28
    s_or_b32 s48, s48, s49
    s_xor_b32 s49, s70, s28
    s_or_b32 s48, s48, s49
    s_xor_b32 s49, s71, s28
    s_or_b32 s48, s48, s49
    s_cmp_eq_u32 s48, 0
    s_cbranch_scc1 spd_65
    s_sleep 4
    s_add_u32 s26, s26, 1
    s_cmp_lt_u32 s26, 40000
    s_cbranch_scc1 sp_64
    v_mov_b32 v250, 4
    v_mov_b32 v251, 0xdead
    buffer_store_dword v251, v250, s[44:47], 0 offen sc1
spd_65:
    s_mov_b32 s26, 0
sp_66:
    s_load_dwordx4 s[56:59], s[50:51], s36 glc
    s_waitcnt lgkmcnt(0)
    s_xor_b32 s48, s56, s28
    s_xor_b32 s49, s57, s28
    s_or_b32 s48, s48, s49
    s_xor_b32 s49, s58, s28
    s_or_b32 s48, s48, s49
    s_xor_b32 s49, s59, s28
    s_or_b32 s48, s48, s49
    s_cmp_eq_u32 s48, 0
    s_cbranch_scc1 spd_67
    s_sleep 4
    s_add_u32 s26, s26, 1
    s_cmp_lt_u32 s26, 40000
    s_cbranch_scc1 sp_66
    v_mov_b32 v250, 4
    v_mov_b32 v251, 0xdead
    buffer_store_dword v251, v250, s[44:47], 0 offen sc1
spd_67:
    v_mov_b32 v24, 156752
    v_mov_b32 v25, 1
    s_mov_b64 s[48:49], exec
    s_mov_b64 exec, 1
    ds_write_b32 v24, v25
    s_mov_b64 exec, s[48:49]
    s_branch zj_63
zo_62:
    s_mov_b32 s26, 0
    v_mov_b32 v24, 156752
ldsw_68:
    ds_read_b32 v25, v24
    s_waitcnt lgkmcnt(0)
    v_readfirstlane_b32 s24, v25
    s_nop 3
    s_cmp_lg_u32 s24, 0
    s_cbranch_scc1 ldswd_69
    s_sleep 2
    s_add_u32 s26, s26, 1
    s_cmp_lt_u32 s26, 800000
    s_cbranch_scc1 ldsw_68
    v_mov_b32 v250, 4
    v_mov_b32 v251, 0xdead
    buffer_store_dword v251, v250, s[44:47], 0 offen sc1
ldswd_69:
zj_63:
    buffer_load_dwordx2 v[6:7], v9, s[52:55], 0 offen sc1
    v_lshrrev_b32 v8, 3, v2
    v_and_b32 v9, 7, v2
    v_lshlrev_b32 v23, 12, v8
    v_lshl_add_u32 v23, v9, 4, v23
    s_lshl_b32 s25, s34, 12
    s_lshl_b32 s26, s30, 7
    s_add_u32 s25, s25, s26
    v_mov_b32 v24, 0x80000000
    v_cmp_gt_u32 vcc, 32, v2
    v_add_u32 v25, 0x10000, v23
    v_add_u32 v26, 0x8000, v23
    v_cndmask_b32 v25, v24, v25, vcc
    buffer_load_dwordx4 v[28:31], v23, s[16:19], s25 offen sc1
    buffer_load_dwordx4 v[32:35], v26, s[16:19], s25 offen sc1
    buffer_load_dwordx4 v[36:39], v25, s[16:19], s25 offen sc1
    s_mul_i32 s24, s27, 21248
    v_add_u32 v5, s24, v3
    s_waitcnt vmcnt(2)
    ds_write_b128 v5, v[28:31]
    s_waitcnt vmcnt(1)
    ds_write_b128 v5, v[32:35] offset:1024
    s_waitcnt vmcnt(0)
    s_mov_b32 exec_hi, 0
    ds_write_b128 v5, v[36:39] offset:2048
    s_mov_b32 exec_hi, -1
    v_lshlrev_b32 v148, 16, v6
    v_mov_b32 v149, v148
    v_mov_b32 v150, v7
    v_mov_b32 v151, v7
    v_lshlrev_b32 v176, 16, v10
    v_and_b32 v177, 0xffff0000, v10
    v_lshlrev_b32 v178, 16, v11
    v_and_b32 v179, 0xffff0000, v11
    v_lshlrev_b32 v180, 16, v12
    v_and_b32 v181, 0xffff0000, v12
    v_lshlrev_b32 v182, 16, v13
    v_and_b32 v183, 0xffff0000, v13
    v_pk_add_f32 v[160:161], v[176:177], v[148:149] neg_lo:[0,1] neg_hi:[0,1]
    v_pk_add_f32 v[162:163], v[178:179], v[148:149] neg_lo:[0,1] neg_hi:[0,1]
    v_pk_add_f32 v[164:165], v[180:181], v[148:149] neg_lo:[0,1] neg_hi:[0,1]
    v_pk_add_f32 v[166:167], v[182:183], v[148:149] neg_lo:[0,1] neg_hi:[0,1]
    v_cvt_pk_bf16_f32 v160, 0, v160
    v_cvt_pk_bf16_f32 v161, 0, v161
    v_cvt_pk_bf16_f32 v162, 0, v162
    v_cvt_pk_bf16_f32 v163, 0, v163
    v_cvt_pk_bf16_f32 v164, 0, v164
    v_cvt_pk_bf16_f32 v165, 0, v165
    v_cvt_pk_bf16_f32 v166, 0, v166
    v_cvt_pk_bf16_f32 v167, 0, v167
    v_pk_mul_f32 v[160:161], v[160:161], v[150:151]
    v_pk_mul_f32 v[162:163], v[162:163], v[150:151]
    v_pk_mul_f32 v[164:165], v[164:165], v[150:151]
    v_pk_mul_f32 v[166:167], v[166:167], v[150:151]
    v_cvt_pk_bf16_f32 v160, 0, v160
    v_cvt_pk_bf16_f32 v161, 0, v161
    v_cvt_pk_bf16_f32 v162, 0, v162
    v_cvt_pk_bf16_f32 v163, 0, v163
    v_cvt_pk_bf16_f32 v164, 0, v164
    v_cvt_pk_bf16_f32 v165, 0, v165
    v_cvt_pk_bf16_f32 v166, 0, v166
    v_cvt_pk_bf16_f32 v167, 0, v167
    s_waitcnt lgkmcnt(0)
    s_barrier
    s_mul_i32 s24, s27, 17408
    s_add_u32 s24, s24, 94208
    v_add_u32 v5, s24, v3
    ds_read_b128 v[24:27], v5 offset:0
    ds_read_b128 v[28:31], v5 offset:1024
    ds_read_b128 v[32:35], v5 offset:2048
    ds_read_b128 v[36:39], v5 offset:3072
    ds_read_b128 v[40:43], v5 offset:4096
    ds_read_b128 v[44:47], v5 offset:5120
    ds_read_b128 v[48:51], v5 offset:6144
    ds_read_b128 v[52:55], v5 offset:7168
    v_and_b32 v8, 15, v2
    v_lshrrev_b32 v9, 4, v2
    v_lshrrev_b32 v22, 2, v8
    v_lshl_add_u32 v22, v9, 2, v22
    v_and_b32 v8, 3, v8
    v_lshlrev_b32 v8, 3, v8
    s_lshl_b32 s24, s27, 5
    v_add_u32 v8, s24, v8
    v_add_u32 v23, 48, v22
    v_mul_u32_u24 v9, 205, v23
    v_lshrrev_b32 v9, 12, v9
    v_mul_u32_u24 v145, 20, v9
    v_sub_u32 v23, v23, v145
    v_mul_u32_u24 v9, 21248, v9
    v_lshl_add_u32 v23, v23, 7, v9
    v_add_u32 v23, v23, v8
    ds_read_b64_tr_b16 v[136:137], v23
    v_add_u32 v23, 64, v22
    v_mul_u32_u24 v9, 205, v23
    v_lshrrev_b32 v9, 12, v9
    v_mul_u32_u24 v145, 20, v9
    v_sub_u32 v23, v23, v145
    v_mul_u32_u24 v9, 21248, v9
    v_lshl_add_u32 v23, v23, 7, v9
    v_add_u32 v23, v23, v8
    ds_read_b64_tr_b16 v[138:139], v23
    s_waitcnt lgkmcnt(0)
    v_pk_add_f32 v[116:117], v[24:25], v[32:33]
    v_pk_add_f32 v[56:57], v[40:41], v[48:49]
    v_pk_add_f32 v[116:117], v[116:117], v[56:57]
    v_pk_add_f32 v[118:119], v[26:27], v[34:35]
    v_pk_add_f32 v[58:59], v[42:43], v[50:51]
    v_pk_add_f32 v[118:119], v[118:119], v[58:59]
    v_pk_add_f32 v[120:121], v[28:29], v[36:37]
    v_pk_add_f32 v[56:57], v[44:45], v[52:53]
    v_pk_add_f32 v[120:121], v[120:121], v[56:57]
    v_pk_add_f32 v[122:123], v[30:31], v[38:39]
    v_pk_add_f32 v[58:59], v[46:47], v[54:55]
    v_pk_add_f32 v[122:123], v[122:123], v[58:59]
    s_mov_b64 s[52:53], s[94:95]
    s_and_b32 s53, s53, 0xffff
    s_mov_b32 s54, 2621440
    s_mov_b32 s55, 0x00020000
    v_mul_f32 v8, v7, v7
    v_mov_b32 v9, v8
    s_mov_b32 s24, 0xbfb8aa3b
    v_pk_mul_f32 v[116:117], v[116:117], v[8:9]
    v_pk_mul_f32 v[118:119], v[118:119], v[8:9]
    v_cvt_pk_bf16_f32 v116, 0, v116
    v_cvt_pk_bf16_f32 v117, 0, v117
    v_cvt_pk_bf16_f32 v118, 0, v118
    v_cvt_pk_bf16_f32 v119, 0, v119
    v_lshlrev_b32 v26, 16, v104
    v_and_b32 v27, 0xffff0000, v104
    v_lshlrev_b32 v38, 16, v105
    v_and_b32 v39, 0xffff0000, v105
    v_pk_add_f32 v[116:117], v[116:117], v[26:27]
    v_pk_add_f32 v[118:119], v[118:119], v[38:39]
    v_cvt_pk_bf16_f32 v116, 0, v116
    v_cvt_pk_bf16_f32 v117, 0, v117
    v_cvt_pk_bf16_f32 v118, 0, v118
    v_cvt_pk_bf16_f32 v119, 0, v119
    v_mul_f32 v26, s24, v116
    v_mul_f32 v27, s24, v117
    v_mul_f32 v38, s24, v118
    v_mul_f32 v39, s24, v119
    v_exp_f32 v26, v26
    v_exp_f32 v27, v27
    v_exp_f32 v38, v38
    v_exp_f32 v39, v39
    v_lshlrev_b32 v32, 16, v136
    v_and_b32 v33, 0xffff0000, v136
    v_lshlrev_b32 v44, 16, v137
    v_and_b32 v45, 0xffff0000, v137
    v_add_f32 v26, 1.0, v26
    v_add_f32 v27, 1.0, v27
    v_add_f32 v38, 1.0, v38
    v_add_f32 v39, 1.0, v39
    v_rcp_f32 v26, v26
    v_rcp_f32 v27, v27
    v_rcp_f32 v38, v38
    v_rcp_f32 v39, v39
    v_pk_mul_f32 v[30:31], v[160:161], v[32:33]
    v_pk_mul_f32 v[42:43], v[162:163], v[44:45]
    v_pk_mul_f32 v[116:117], v[116:117], v[26:27]
    v_pk_mul_f32 v[118:119], v[118:119], v[38:39]
    v_cvt_pk_bf16_f32 v30, 0, v30
    v_cvt_pk_bf16_f32 v31, 0, v31
    v_cvt_pk_bf16_f32 v42, 0, v42
    v_cvt_pk_bf16_f32 v43, 0, v43
    v_cvt_pk_bf16_f32 v116, 0, v116
    v_cvt_pk_bf16_f32 v117, 0, v117
    v_cvt_pk_bf16_f32 v118, 0, v118
    v_cvt_pk_bf16_f32 v119, 0, v119
    v_pk_mul_f32 v[30:31], v[30:31], v[116:117]
    v_pk_mul_f32 v[42:43], v[42:43], v[118:119]
    v_cvt_pk_bf16_f32 v30, 0, v30
    v_cvt_pk_bf16_f32 v31, 0, v31
    v_cvt_pk_bf16_f32 v42, 0, v42
    v_cvt_pk_bf16_f32 v43, 0, v43
    v_pk_add_f32 v[30:31], v[30:31], v[176:177]
    v_pk_add_f32 v[42:43], v[42:43], v[178:179]
    v_cvt_pk_bf16_f32 v152, v30, v31
    v_cvt_pk_bf16_f32 v153, v42, v43
    buffer_store_dwordx2 v[152:153], v20, s[52:55], 0 offen offset:96
    v_pk_mul_f32 v[120:121], v[120:121], v[8:9]
    v_pk_mul_f32 v[122:123], v[122:123], v[8:9]
    v_cvt_pk_bf16_f32 v120, 0, v120
    v_cvt_pk_bf16_f32 v121, 0, v121
    v_cvt_pk_bf16_f32 v122, 0, v122
    v_cvt_pk_bf16_f32 v123, 0, v123
    v_lshlrev_b32 v26, 16, v106
    v_and_b32 v27, 0xffff0000, v106
    v_lshlrev_b32 v38, 16, v107
    v_and_b32 v39, 0xffff0000, v107
    v_pk_add_f32 v[120:121], v[120:121], v[26:27]
    v_pk_add_f32 v[122:123], v[122:123], v[38:39]
    v_cvt_pk_bf16_f32 v120, 0, v120
    v_cvt_pk_bf16_f32 v121, 0, v121
    v_cvt_pk_bf16_f32 v122, 0, v122
    v_cvt_pk_bf16_f32 v123, 0, v123
    v_mul_f32 v26, s24, v120
    v_mul_f32 v27, s24, v121
    v_mul_f32 v38, s24, v122
    v_mul_f32 v39, s24, v123
    v_exp_f32 v26, v26
    v_exp_f32 v27, v27
    v_exp_f32 v38, v38
    v_exp_f32 v39, v39
    v_lshlrev_b32 v32, 16, v138
    v_and_b32 v33, 0xffff0000, v138
    v_lshlrev_b32 v44, 16, v139
    v_and_b32 v45, 0xffff0000, v139
    v_add_f32 v26, 1.0, v26
    v_add_f32 v27, 1.0, v27
    v_add_f32 v38, 1.0, v38
    v_add_f32 v39, 1.0, v39
    v_rcp_f32 v26, v26
    v_rcp_f32 v27, v27
    v_rcp_f32 v38, v38
    v_rcp_f32 v39, v39
    v_pk_mul_f32 v[30:31], v[164:165], v[32:33]
    v_pk_mul_f32 v[42:43], v[166:167], v[44:45]
    v_pk_mul_f32 v[120:121], v[120:121], v[26:27]
    v_pk_mul_f32 v[122:123], v[122:123], v[38:39]
    v_cvt_pk_bf16_f32 v30, 0, v30
    v_cvt_pk_bf16_f32 v31, 0, v31
    v_cvt_pk_bf16_f32 v42, 0, v42
    v_cvt_pk_bf16_f32 v43, 0, v43
    v_cvt_pk_bf16_f32 v120, 0, v120
    v_cvt_pk_bf16_f32 v121, 0, v121
    v_cvt_pk_bf16_f32 v122, 0, v122
    v_cvt_pk_bf16_f32 v123, 0, v123
    v_pk_mul_f32 v[30:31], v[30:31], v[120:121]
    v_pk_mul_f32 v[42:43], v[42:43], v[122:123]
    v_cvt_pk_bf16_f32 v30, 0, v30
    v_cvt_pk_bf16_f32 v31, 0, v31
    v_cvt_pk_bf16_f32 v42, 0, v42
    v_cvt_pk_bf16_f32 v43, 0, v43
    v_pk_add_f32 v[30:31], v[30:31], v[180:181]
    v_pk_add_f32 v[42:43], v[42:43], v[182:183]
    v_cvt_pk_bf16_f32 v154, v30, v31
    v_cvt_pk_bf16_f32 v155, v42, v43
    buffer_store_dwordx2 v[154:155], v20, s[52:55], 0 offen offset:128
    s_endpgm
L_gemm2:
    s_cmp_lg_u32 s29, 0
    s_cbranch_scc1 ho_70
    s_lshl_b32 s27, s2, 9
    s_add_u32 s27, s27, 194560
    s_mov_b32 s26, 0
sp_72:
    s_load_dwordx16 s[56:71], s[50:51], s27 glc
    s_waitcnt lgkmcnt(0)
    s_xor_b32 s48, s56, s28
    s_xor_b32 s49, s57, s28
    s_or_b32 s48, s48, s49
    s_xor_b32 s49, s58, s28
    s_or_b32 s48, s48, s49
    s_xor_b32 s49, s59, s28
    s_or_b32 s48, s48, s49
    s_xor_b32 s49, s60, s28
    s_or_b32 s48, s48, s49
    s_xor_b32 s49, s61, s28
    s_or_b32 s48, s48, s49
    s_xor_b32 s49, s62, s28
    s_or_b32 s48, s48, s49
    s_xor_b32 s49, s63, s28
    s_or_b32 s48, s48, s49
    s_xor_b32 s49, s64, s28
    s_or_b32 s48, s48, s49
    s_xor_b32 s49, s65, s28
    s_or_b32 s48, s48, s49
    s_xor_b32 s49, s66, s28
    s_or_b32 s48, s48, s49
    s_xor_b32 s49, s67, s28
    s_or_b32 s48, s48, s49
    s_cmp_eq_u32 s48, 0
    s_cbranch_scc1 spd_73
    s_sleep 2
    s_add_u32 s26, s26, 1
    s_cmp_lt_u32 s26, 40000
    s_cbranch_scc1 sp_72
    v_mov_b32 v250, 4
    v_mov_b32 v251, 0xdead
    buffer_store_dword v251, v250, s[44:47], 0 offen sc1
spd_73:
    v_mov_b32 v24, 156748
    v_mov_b32 v25, 1
    s_mov_b64 s[48:49], exec
    s_mov_b64 exec, 1
    ds_write_b32 v24, v25
    s_mov_b64 exec, s[48:49]
    s_branch hj_71
ho_70:
    s_mov_b32 s26, 0
    v_mov_b32 v24, 156748
ldsw_74:
    ds_read_b32 v25, v24
    s_waitcnt lgkmcnt(0)
    v_readfirstlane_b32 s24, v25
    s_nop 3
    s_cmp_lg_u32 s24, 0
    s_cbranch_scc1 ldswd_75
    s_sleep 2
    s_add_u32 s26, s26, 1
    s_cmp_lt_u32 s26, 800000
    s_cbranch_scc1 ldsw_74
    v_mov_b32 v250, 4
    v_mov_b32 v251, 0xdead
    buffer_store_dword v251, v250, s[44:47], 0 offen sc1
ldswd_75:
hj_71:
    buffer_load_dwordx2 v[6:7], v9, s[52:55], 0 offen sc1
    buffer_load_dwordx4 v[104:107], v3, s[4:7], s32 offen offset:0 sc1
    buffer_load_dwordx4 v[108:111], v3, s[4:7], s32 offen offset:1024 sc1
    buffer_load_dwordx4 v[112:115], v3, s[4:7], s32 offen offset:2048 sc1
    buffer_load_dwordx4 v[116:119], v3, s[4:7], s32 offen offset:3072 sc1
    s_add_u32 s32, s32, 4096
    buffer_load_dwordx4 v[140:143], v3, s[4:7], s32 offen offset:0 sc1
    buffer_load_dwordx4 v[144:147], v3, s[4:7], s32 offen offset:1024 sc1
    buffer_load_dwordx4 v[148:151], v3, s[4:7], s32 offen offset:2048 sc1
    buffer_load_dwordx4 v[152:155], v3, s[4:7], s32 offen offset:3072 sc1
    s_add_u32 s32, s32, 4096
    buffer_load_dwordx4 v[176:179], v3, s[4:7], s32 offen offset:0 sc1
    buffer_load_dwordx4 v[180:183], v3, s[4:7], s32 offen offset:1024 sc1
    buffer_load_dwordx4 v[184:187], v3, s[4:7], s32 offen offset:2048 sc1
    buffer_load_dwordx4 v[188:191], v3, s[4:7], s32 offen offset:3072 sc1
    s_add_u32 s32, s32, 4096
    buffer_load_dwordx4 v[212:215], v3, s[4:7], s32 offen offset:0 sc1
    buffer_load_dwordx4 v[216:219], v3, s[4:7], s32 offen offset:1024 sc1
    buffer_load_dwordx4 v[220:223], v3, s[4:7], s32 offen offset:2048 sc1
    buffer_load_dwordx4 v[224:227], v3, s[4:7], s32 offen offset:3072 sc1
    s_add_u32 s32, s32, 4096
    s_waitcnt vmcnt(12)
    v_mfma_f32_16x16x32_bf16 v[24:27], v[120:123], v[104:107], 0
    v_mfma_f32_16x16x32_bf16 v[28:31], v[120:123], v[108:111], 0
    v_mfma_f32_16x16x32_bf16 v[32:35], v[120:123], v[112:115], 0
    v_mfma_f32_16x16x32_bf16 v[36:39], v[120:123], v[116:119], 0
    v_mfma_f32_16x16x32_bf16 v[40:43], v[124:127], v[104:107], 0
    v_mfma_f32_16x16x32_bf16 v[44:47], v[124:127], v[108:111], 0
    v_mfma_f32_16x16x32_bf16 v[48:51], v[124:127], v[112:115], 0
    v_mfma_f32_16x16x32_bf16 v[52:55], v[124:127], v[116:119], 0
    v_mfma_f32_16x16x32_bf16 v[56:59], v[128:131], v[104:107], 0
    v_mfma_f32_16x16x32_bf16 v[60:63], v[128:131], v[108:111], 0
    v_mfma_f32_16x16x32_bf16 v[64:67], v[128:131], v[112:115], 0
    v_mfma_f32_16x16x32_bf16 v[68:71], v[128:131], v[116:119], 0
    v_mfma_f32_16x16x32_bf16 v[72:75], v[132:135], v[104:107], 0
    v_mfma_f32_16x16x32_bf16 v[76:79], v[132:135], v[108:111], 0
    v_mfma_f32_16x16x32_bf16 v[80:83], v[132:135], v[112:115], 0
    v_mfma_f32_16x16x32_bf16 v[84:87], v[132:135], v[116:119], 0
    v_mfma_f32_16x16x32_bf16 v[88:91], v[136:139], v[104:107], 0
    v_mfma_f32_16x16x32_bf16 v[92:95], v[136:139], v[108:111], 0
    v_mfma_f32_16x16x32_bf16 v[96:99], v[136:139], v[112:115], 0
    v_mfma_f32_16x16x32_bf16 v[100:103], v[136:139], v[116:119], 0
    buffer_load_dwordx4 v[120:123], v3, s[8:11], s33 offen offset:0 sc1
    buffer_load_dwordx4 v[124:127], v3, s[8:11], s33 offen offset:1024 sc1
    buffer_load_dwordx4 v[128:131], v3, s[8:11], s33 offen offset:2048 sc1
    buffer_load_dwordx4 v[132:135], v3, s[8:11], s33 offen offset:3072 sc1
    buffer_load_dwordx4 v[136:139], v4, s[8:11], s33 offen sc1
    s_add_u32 s33, s33, 5120
    buffer_load_dwordx4 v[104:107], v3, s[4:7], s32 offen offset:0 sc1
    buffer_load_dwordx4 v[108:111], v3, s[4:7], s32 offen offset:1024 sc1
    buffer_load_dwordx4 v[112:115], v3, s[4:7], s32 offen offset:2048 sc1
    buffer_load_dwordx4 v[116:119], v3, s[4:7], s32 offen offset:3072 sc1
    s_add_u32 s32, s32, 4096
    s_waitcnt vmcnt(17)
    v_mfma_f32_16x16x32_bf16 v[24:27], v[156:159], v[140:143], v[24:27]
    v_mfma_f32_16x16x32_bf16 v[28:31], v[156:159], v[144:147], v[28:31]
    v_mfma_f32_16x16x32_bf16 v[32:35], v[156:159], v[148:151], v[32:35]
    v_mfma_f32_16x16x32_bf16 v[36:39], v[156:159], v[152:155], v[36:39]
    v_mfma_f32_16x16x32_bf16 v[40:43], v[160:163], v[140:143], v[40:43]
    v_mfma_f32_16x16x32_bf16 v[44:47], v[160:163], v[144:147], v[44:47]
    v_mfma_f32_16x16x32_bf16 v[48:51], v[160:163], v[148:151], v[48:51]
    v_mfma_f32_16x16x32_bf16 v[52:55], v[160:163], v[152:155], v[52:55]
    v_mfma_f32_16x16x32_bf16 v[56:59], v[164:167], v[140:143], v[56:59]
    v_mfma_f32_16x16x32_bf16 v[60:63], v[164:167], v[144:147], v[60:63]
    v_mfma_f32_16x16x32_bf16 v[64:67], v[164:167], v[148:151], v[64:67]
    v_mfma_f32_16x16x32_bf16 v[68:71], v[164:167], v[152:155], v[68:71]
    v_mfma_f32_16x16x32_bf16 v[72:75], v[168:171], v[140:143], v[72:75]
    v_mfma_f32_16x16x32_bf16 v[76:79], v[168:171], v[144:147], v[76:79]
    v_mfma_f32_16x16x32_bf16 v[80:83], v[168:171], v[148:151], v[80:83]
    v_mfma_f32_16x16x32_bf16 v[84:87], v[168:171], v[152:155], v[84:87]
    v_mfma_f32_16x16x32_bf16 v[88:91], v[172:175], v[140:143], v[88:91]
    v_mfma_f32_16x16x32_bf16 v[92:95], v[172:175], v[144:147], v[92:95]
    v_mfma_f32_16x16x32_bf16 v[96:99], v[172:175], v[148:151], v[96:99]
    v_mfma_f32_16x16x32_bf16 v[100:103], v[172:175], v[152:155], v[100:103]
    buffer_load_dwordx4 v[156:159], v3, s[8:11], s33 offen offset:0 sc1
    buffer_load_dwordx4 v[160:163], v3, s[8:11], s33 offen offset:1024 sc1
    buffer_load_dwordx4 v[164:167], v3, s[8:11], s33 offen offset:2048 sc1
    buffer_load_dwordx4 v[168:171], v3, s[8:11], s33 offen offset:3072 sc1
    buffer_load_dwordx4 v[172:175], v4, s[8:11], s33 offen sc1
    s_add_u32 s33, s33, 5120
    buffer_load_dwordx4 v[140:143], v3, s[4:7], s32 offen offset:0 sc1
    buffer_load_dwordx4 v[144:147], v3, s[4:7], s32 offen offset:1024 sc1
    buffer_load_dwordx4 v[148:151], v3, s[4:7], s32 offen offset:2048 sc1
    buffer_load_dwordx4 v[152:155], v3, s[4:7], s32 offen offset:3072 sc1
    s_add_u32 s32, s32, 4096
    s_waitcnt vmcnt(22)
    v_mfma_f32_16x16x32_bf16 v[24:27], v[192:195], v[176:179], v[24:27]
    v_mfma_f32_16x16x32_bf16 v[28:31], v[192:195], v[180:183], v[28:31]
    v_mfma_f32_16x16x32_bf16 v[32:35], v[192:195], v[184:187], v[32:35]
    v_mfma_f32_16x16x32_bf16 v[36:39], v[192:195], v[188:191], v[36:39]
    v_mfma_f32_16x16x32_bf16 v[40:43], v[196:199], v[176:179], v[40:43]
    v_mfma_f32_16x16x32_bf16 v[44:47], v[196:199], v[180:183], v[44:47]
    v_mfma_f32_16x16x32_bf16 v[48:51], v[196:199], v[184:187], v[48:51]
    v_mfma_f32_16x16x32_bf16 v[52:55], v[196:199], v[188:191], v[52:55]
    v_mfma_f32_16x16x32_bf16 v[56:59], v[200:203], v[176:179], v[56:59]
    v_mfma_f32_16x16x32_bf16 v[60:63], v[200:203], v[180:183], v[60:63]
    v_mfma_f32_16x16x32_bf16 v[64:67], v[200:203], v[184:187], v[64:67]
    v_mfma_f32_16x16x32_bf16 v[68:71], v[200:203], v[188:191], v[68:71]
    v_mfma_f32_16x16x32_bf16 v[72:75], v[204:207], v[176:179], v[72:75]
    v_mfma_f32_16x16x32_bf16 v[76:79], v[204:207], v[180:183], v[76:79]
    v_mfma_f32_16x16x32_bf16 v[80:83], v[204:207], v[184:187], v[80:83]
    v_mfma_f32_16x16x32_bf16 v[84:87], v[204:207], v[188:191], v[84:87]
    v_mfma_f32_16x16x32_bf16 v[88:91], v[208:211], v[176:179], v[88:91]
    v_mfma_f32_16x16x32_bf16 v[92:95], v[208:211], v[180:183], v[92:95]
    v_mfma_f32_16x16x32_bf16 v[96:99], v[208:211], v[184:187], v[96:99]
    v_mfma_f32_16x16x32_bf16 v[100:103], v[208:211], v[188:191], v[100:103]
    buffer_load_dwordx4 v[192:195], v3, s[8:11], s33 offen offset:0 sc1
    buffer_load_dwordx4 v[196:199], v3, s[8:11], s33 offen offset:1024 sc1
    buffer_load_dwordx4 v[200:203], v3, s[8:11], s33 offen offset:2048 sc1
    buffer_load_dwordx4 v[204:207], v3, s[8:11], s33 offen offset:3072 sc1
    buffer_load_dwordx4 v[208:211], v4, s[8:11], s33 offen sc1
    s_add_u32 s33, s33, 5120
    buffer_load_dwordx4 v[176:179], v3, s[4:7], s32 offen offset:0 sc1
    buffer_load_dwordx4 v[180:183], v3, s[4:7], s32 offen offset:1024 sc1
    buffer_load_dwordx4 v[184:187], v3, s[4:7], s32 offen offset:2048 sc1
    buffer_load_dwordx4 v[188:191], v3, s[4:7], s32 offen offset:3072 sc1
    s_add_u32 s32, s32, 4096
    s_waitcnt vmcnt(27)
    v_mfma_f32_16x16x32_bf16 v[24:27], v[228:231], v[212:215], v[24:27]
    v_mfma_f32_16x16x32_bf16 v[28:31], v[228:231], v[216:219], v[28:31]
    v_mfma_f32_16x16x32_bf16 v[32:35], v[228:231], v[220:223], v[32:35]
    v_mfma_f32_16x16x32_bf16 v[36:39], v[228:231], v[224:227], v[36:39]
    v_mfma_f32_16x16x32_bf16 v[40:43], v[232:235], v[212:215], v[40:43]
    v_mfma_f32_16x16x32_bf16 v[44:47], v[232:235], v[216:219], v[44:47]
    v_mfma_f32_16x16x32_bf16 v[48:51], v[232:235], v[220:223], v[48:51]
    v_mfma_f32_16x16x32_bf16 v[52:55], v[232:235], v[224:227], v[52:55]
    v_mfma_f32_16x16x32_bf16 v[56:59], v[236:239], v[212:215], v[56:59]
    v_mfma_f32_16x16x32_bf16 v[60:63], v[236:239], v[216:219], v[60:63]
    v_mfma_f32_16x16x32_bf16 v[64:67], v[236:239], v[220:223], v[64:67]
    v_mfma_f32_16x16x32_bf16 v[68:71], v[236:239], v[224:227], v[68:71]
    v_mfma_f32_16x16x32_bf16 v[72:75], v[240:243], v[212:215], v[72:75]
    v_mfma_f32_16x16x32_bf16 v[76:79], v[240:243], v[216:219], v[76:79]
    v_mfma_f32_16x16x32_bf16 v[80:83], v[240:243], v[220:223], v[80:83]
    v_mfma_f32_16x16x32_bf16 v[84:87], v[240:243], v[224:227], v[84:87]
    v_mfma_f32_16x16x32_bf16 v[88:91], v[244:247], v[212:215], v[88:91]
    v_mfma_f32_16x16x32_bf16 v[92:95], v[244:247], v[216:219], v[92:95]
    v_mfma_f32_16x16x32_bf16 v[96:99], v[244:247], v[220:223], v[96:99]
    v_mfma_f32_16x16x32_bf16 v[100:103], v[244:247], v[224:227], v[100:103]
    buffer_load_dwordx4 v[228:231], v3, s[8:11], s33 offen offset:0 sc1
    buffer_load_dwordx4 v[232:235], v3, s[8:11], s33 offen offset:1024 sc1
    buffer_load_dwordx4 v[236:239], v3, s[8:11], s33 offen offset:2048 sc1
    buffer_load_dwordx4 v[240:243], v3, s[8:11], s33 offen offset:3072 sc1
    buffer_load_dwordx4 v[244:247], v4, s[8:11], s33 offen sc1
    s_add_u32 s33, s33, 5120
    buffer_load_dwordx4 v[212:215], v3, s[4:7], s32 offen offset:0 sc1
    buffer_load_dwordx4 v[216:219], v3, s[4:7], s32 offen offset:1024 sc1
    buffer_load_dwordx4 v[220:223], v3, s[4:7], s32 offen offset:2048 sc1
    buffer_load_dwordx4 v[224:227], v3, s[4:7], s32 offen offset:3072 sc1
    s_add_u32 s32, s32, 4096
    s_cmp_lg_u32 s29, 0
    s_cbranch_scc1 g2s_76
    v_mov_b32 v17, 156736
    v_mov_b32 v19, 1
    ds_write_b32 v17, v19
g2s_76:
    s_waitcnt vmcnt(27)
    v_mfma_f32_16x16x32_bf16 v[24:27], v[120:123], v[104:107], v[24:27]
    v_mfma_f32_16x16x32_bf16 v[28:31], v[120:123], v[108:111], v[28:31]
    v_mfma_f32_16x16x32_bf16 v[32:35], v[120:123], v[112:115], v[32:35]
    v_mfma_f32_16x16x32_bf16 v[36:39], v[120:123], v[116:119], v[36:39]
    v_mfma_f32_16x16x32_bf16 v[40:43], v[124:127], v[104:107], v[40:43]
    v_mfma_f32_16x16x32_bf16 v[44:47], v[124:127], v[108:111], v[44:47]
    v_mfma_f32_16x16x32_bf16 v[48:51], v[124:127], v[112:115], v[48:51]
    v_mfma_f32_16x16x32_bf16 v[52:55], v[124:127], v[116:119], v[52:55]
    v_mfma_f32_16x16x32_bf16 v[56:59], v[128:131], v[104:107], v[56:59]
    v_mfma_f32_16x16x32_bf16 v[60:63], v[128:131], v[108:111], v[60:63]
    v_mfma_f32_16x16x32_bf16 v[64:67], v[128:131], v[112:115], v[64:67]
    v_mfma_f32_16x16x32_bf16 v[68:71], v[128:131], v[116:119], v[68:71]
    v_mfma_f32_16x16x32_bf16 v[72:75], v[132:135], v[104:107], v[72:75]
    v_mfma_f32_16x16x32_bf16 v[76:79], v[132:135], v[108:111], v[76:79]
    v_mfma_f32_16x16x32_bf16 v[80:83], v[132:135], v[112:115], v[80:83]
    v_mfma_f32_16x16x32_bf16 v[84:87], v[132:135], v[116:119], v[84:87]
    v_mfma_f32_16x16x32_bf16 v[88:91], v[136:139], v[104:107], v[88:91]
    v_mfma_f32_16x16x32_bf16 v[92:95], v[136:139], v[108:111], v[92:95]
    v_mfma_f32_16x16x32_bf16 v[96:99], v[136:139], v[112:115], v[96:99]
    v_mfma_f32_16x16x32_bf16 v[100:103], v[136:139], v[116:119], v[100:103]
    buffer_load_dwordx4 v[120:123], v3, s[8:11], s33 offen offset:0 sc1
    buffer_load_dwordx4 v[124:127], v3, s[8:11], s33 offen offset:1024 sc1
    buffer_load_dwordx4 v[128:131], v3, s[8:11], s33 offen offset:2048 sc1
    buffer_load_dwordx4 v[132:135], v3, s[8:11], s33 offen offset:3072 sc1
    buffer_load_dwordx4 v[136:139], v4, s[8:11], s33 offen sc1
    s_add_u32 s33, s33, 5120
    buffer_load_dwordx4 v[104:107], v3, s[4:7], s32 offen offset:0 sc1
    buffer_load_dwordx4 v[108:111], v3, s[4:7], s32 offen offset:1024 sc1
    buffer_load_dwordx4 v[112:115], v3, s[4:7], s32 offen offset:2048 sc1
    buffer_load_dwordx4 v[116:119], v3, s[4:7], s32 offen offset:3072 sc1
    s_add_u32 s32, s32, 4096
    s_waitcnt vmcnt(27)
    v_mfma_f32_16x16x32_bf16 v[24:27], v[156:159], v[140:143], v[24:27]
    v_mfma_f32_16x16x32_bf16 v[28:31], v[156:159], v[144:147], v[28:31]
    v_mfma_f32_16x16x32_bf16 v[32:35], v[156:159], v[148:151], v[32:35]
    v_mfma_f32_16x16x32_bf16 v[36:39], v[156:159], v[152:155], v[36:39]
    v_mfma_f32_16x16x32_bf16 v[40:43], v[160:163], v[140:143], v[40:43]
    v_mfma_f32_16x16x32_bf16 v[44:47], v[160:163], v[144:147], v[44:47]
    v_mfma_f32_16x16x32_bf16 v[48:51], v[160:163], v[148:151], v[48:51]
    v_mfma_f32_16x16x32_bf16 v[52:55], v[160:163], v[152:155], v[52:55]
    v_mfma_f32_16x16x32_bf16 v[56:59], v[164:167], v[140:143], v[56:59]
    v_mfma_f32_16x16x32_bf16 v[60:63], v[164:167], v[144:147], v[60:63]
    v_mfma_f32_16x16x32_bf16 v[64:67], v[164:167], v[148:151], v[64:67]
    v_mfma_f32_16x16x32_bf16 v[68:71], v[164:167], v[152:155], v[68:71]
    v_mfma_f32_16x16x32_bf16 v[72:75], v[168:171], v[140:143], v[72:75]
    v_mfma_f32_16x16x32_bf16 v[76:79], v[168:171], v[144:147], v[76:79]
    v_mfma_f32_16x16x32_bf16 v[80:83], v[168:171], v[148:151], v[80:83]
    v_mfma_f32_16x16x32_bf16 v[84:87], v[168:171], v[152:155], v[84:87]
    v_mfma_f32_16x16x32_bf16 v[88:91], v[172:175], v[140:143], v[88:91]
    v_mfma_f32_16x16x32_bf16 v[92:95], v[172:175], v[144:147], v[92:95]
    v_mfma_f32_16x16x32_bf16 v[96:99], v[172:175], v[148:151], v[96:99]
    v_mfma_f32_16x16x32_bf16 v[100:103], v[172:175], v[152:155], v[100:103]
    buffer_load_dwordx4 v[156:159], v3, s[8:11], s33 offen offset:0 sc1
    buffer_load_dwordx4 v[160:163], v3, s[8:11], s33 offen offset:1024 sc1
    buffer_load_dwordx4 v[164:167], v3, s[8:11], s33 offen offset:2048 sc1
    buffer_load_dwordx4 v[168:171], v3, s[8:11], s33 offen offset:3072 sc1
    buffer_load_dwordx4 v[172:175], v4, s[8:11], s33 offen sc1
    s_add_u32 s33, s33, 5120
    buffer_load_dwordx4 v[140:143], v3, s[4:7], s32 offen offset:0 sc1
    buffer_load_dwordx4 v[144:147], v3, s[4:7], s32 offen offset:1024 sc1
    buffer_load_dwordx4 v[148:151], v3, s[4:7], s32 offen offset:2048 sc1
    buffer_load_dwordx4 v[152:155], v3, s[4:7], s32 offen offset:3072 sc1
    s_add_u32 s32, s32, 4096
    s_waitcnt vmcnt(27)
    v_mfma_f32_16x16x32_bf16 v[24:27], v[192:195], v[176:179], v[24:27]
    v_mfma_f32_16x16x32_bf16 v[28:31], v[192:195], v[180:183], v[28:31]
    v_mfma_f32_16x16x32_bf16 v[32:35], v[192:195], v[184:187], v[32:35]
    v_mfma_f32_16x16x32_bf16 v[36:39], v[192:195], v[188:191], v[36:39]
    v_mfma_f32_16x16x32_bf16 v[40:43], v[196:199], v[176:179], v[40:43]
    v_mfma_f32_16x16x32_bf16 v[44:47], v[196:199], v[180:183], v[44:47]
    v_mfma_f32_16x16x32_bf16 v[48:51], v[196:199], v[184:187], v[48:51]
    v_mfma_f32_16x16x32_bf16 v[52:55], v[196:199], v[188:191], v[52:55]
    v_mfma_f32_16x16x32_bf16 v[56:59], v[200:203], v[176:179], v[56:59]
    v_mfma_f32_16x16x32_bf16 v[60:63], v[200:203], v[180:183], v[60:63]
    v_mfma_f32_16x16x32_bf16 v[64:67], v[200:203], v[184:187], v[64:67]
    v_mfma_f32_16x16x32_bf16 v[68:71], v[200:203], v[188:191], v[68:71]
    v_mfma_f32_16x16x32_bf16 v[72:75], v[204:207], v[176:179], v[72:75]
    v_mfma_f32_16x16x32_bf16 v[76:79], v[204:207], v[180:183], v[76:79]
    v_mfma_f32_16x16x32_bf16 v[80:83], v[204:207], v[184:187], v[80:83]
    v_mfma_f32_16x16x32_bf16 v[84:87], v[204:207], v[188:191], v[84:87]
    v_mfma_f32_16x16x32_bf16 v[88:91], v[208:211], v[176:179], v[88:91]
    v_mfma_f32_16x16x32_bf16 v[92:95], v[208:211], v[180:183], v[92:95]
    v_mfma_f32_16x16x32_bf16 v[96:99], v[208:211], v[184:187], v[96:99]
    v_mfma_f32_16x16x32_bf16 v[100:103], v[208:211], v[188:191], v[100:103]
    buffer_load_dwordx4 v[192:195], v3, s[8:11], s33 offen offset:0 sc1
    buffer_load_dwordx4 v[196:199], v3, s[8:11], s33 offen offset:1024 sc1
    buffer_load_dwordx4 v[200:203], v3, s[8:11], s33 offen offset:2048 sc1
    buffer_load_dwordx4 v[204:207], v3, s[8:11], s33 offen offset:3072 sc1
    buffer_load_dwordx4 v[208:211], v4, s[8:11], s33 offen sc1
    s_add_u32 s33, s33, 5120
    buffer_load_dwordx4 v[176:179], v3, s[4:7], s32 offen offset:0 sc1
    buffer_load_dwordx4 v[180:183], v3, s[4:7], s32 offen offset:1024 sc1
    buffer_load_dwordx4 v[184:187], v3, s[4:7], s32 offen offset:2048 sc1
    buffer_load_dwordx4 v[188:191], v3, s[4:7], s32 offen offset:3072 sc1
    s_add_u32 s32, s32, 4096
    s_waitcnt vmcnt(27)
    v_mfma_f32_16x16x32_bf16 v[24:27], v[228:231], v[212:215], v[24:27]
    v_mfma_f32_16x16x32_bf16 v[28:31], v[228:231], v[216:219], v[28:31]
    v_mfma_f32_16x16x32_bf16 v[32:35], v[228:231], v[220:223], v[32:35]
    v_mfma_f32_16x16x32_bf16 v[36:39], v[228:231], v[224:227], v[36:39]
    v_mfma_f32_16x16x32_bf16 v[40:43], v[232:235], v[212:215], v[40:43]
    v_mfma_f32_16x16x32_bf16 v[44:47], v[232:235], v[216:219], v[44:47]
    v_mfma_f32_16x16x32_bf16 v[48:51], v[232:235], v[220:223], v[48:51]
    v_mfma_f32_16x16x32_bf16 v[52:55], v[232:235], v[224:227], v[52:55]
    v_mfma_f32_16x16x32_bf16 v[56:59], v[236:239], v[212:215], v[56:59]
    v_mfma_f32_16x16x32_bf16 v[60:63], v[236:239], v[216:219], v[60:63]
    v_mfma_f32_16x16x32_bf16 v[64:67], v[236:239], v[220:223], v[64:67]
    v_mfma_f32_16x16x32_bf16 v[68:71], v[236:239], v[224:227], v[68:71]
    v_mfma_f32_16x16x32_bf16 v[72:75], v[240:243], v[212:215], v[72:75]
    v_mfma_f32_16x16x32_bf16 v[76:79], v[240:243], v[216:219], v[76:79]
    v_mfma_f32_16x16x32_bf16 v[80:83], v[240:243], v[220:223], v[80:83]
    v_mfma_f32_16x16x32_bf16 v[84:87], v[240:243], v[224:227], v[84:87]
    v_mfma_f32_16x16x32_bf16 v[88:91], v[244:247], v[212:215], v[88:91]
    v_mfma_f32_16x16x32_bf16 v[92:95], v[244:247], v[216:219], v[92:95]
    v_mfma_f32_16x16x32_bf16 v[96:99], v[244:247], v[220:223], v[96:99]
    v_mfma_f32_16x16x32_bf16 v[100:103], v[244:247], v[224:227], v[100:103]
    buffer_load_dwordx4 v[228:231], v3, s[8:11], s33 offen offset:0 sc1
    buffer_load_dwordx4 v[232:235], v3, s[8:11], s33 offen offset:1024 sc1
    buffer_load_dwordx4 v[236:239], v3, s[8:11], s33 offen offset:2048 sc1
    buffer_load_dwordx4 v[240:243], v3, s[8:11], s33 offen offset:3072 sc1
    buffer_load_dwordx4 v[244:247], v4, s[8:11], s33 offen sc1
    s_add_u32 s33, s33, 5120
    buffer_load_dwordx4 v[212:215], v3, s[4:7], s32 offen offset:0 sc1
    buffer_load_dwordx4 v[216:219], v3, s[4:7], s32 offen offset:1024 sc1
    buffer_load_dwordx4 v[220:223], v3, s[4:7], s32 offen offset:2048 sc1
    buffer_load_dwordx4 v[224:227], v3, s[4:7], s32 offen offset:3072 sc1
    s_add_u32 s32, s32, 4096
    s_waitcnt vmcnt(27)
    v_mfma_f32_16x16x32_bf16 v[24:27], v[120:123], v[104:107], v[24:27]
    v_mfma_f32_16x16x32_bf16 v[28:31], v[120:123], v[108:111], v[28:31]
    v_mfma_f32_16x16x32_bf16 v[32:35], v[120:123], v[112:115], v[32:35]
    v_mfma_f32_16x16x32_bf16 v[36:39], v[120:123], v[116:119], v[36:39]
    v_mfma_f32_16x16x32_bf16 v[40:43], v[124:127], v[104:107], v[40:43]
    v_mfma_f32_16x16x32_bf16 v[44:47], v[124:127], v[108:111], v[44:47]
    v_mfma_f32_16x16x32_bf16 v[48:51], v[124:127], v[112:115], v[48:51]
    v_mfma_f32_16x16x32_bf16 v[52:55], v[124:127], v[116:119], v[52:55]
    v_mfma_f32_16x16x32_bf16 v[56:59], v[128:131], v[104:107], v[56:59]
    v_mfma_f32_16x16x32_bf16 v[60:63], v[128:131], v[108:111], v[60:63]
    v_mfma_f32_16x16x32_bf16 v[64:67], v[128:131], v[112:115], v[64:67]
    v_mfma_f32_16x16x32_bf16 v[68:71], v[128:131], v[116:119], v[68:71]
    v_mfma_f32_16x16x32_bf16 v[72:75], v[132:135], v[104:107], v[72:75]
    v_mfma_f32_16x16x32_bf16 v[76:79], v[132:135], v[108:111], v[76:79]
    v_mfma_f32_16x16x32_bf16 v[80:83], v[132:135], v[112:115], v[80:83]
    v_mfma_f32_16x16x32_bf16 v[84:87], v[132:135], v[116:119], v[84:87]
    v_mfma_f32_16x16x32_bf16 v[88:91], v[136:139], v[104:107], v[88:91]
    v_mfma_f32_16x16x32_bf16 v[92:95], v[136:139], v[108:111], v[92:95]
    v_mfma_f32_16x16x32_bf16 v[96:99], v[136:139], v[112:115], v[96:99]
    v_mfma_f32_16x16x32_bf16 v[100:103], v[136:139], v[116:119], v[100:103]
    s_waitcnt vmcnt(18)
    v_mfma_f32_16x16x32_bf16 v[24:27], v[156:159], v[140:143], v[24:27]
    v_mfma_f32_16x16x32_bf16 v[28:31], v[156:159], v[144:147], v[28:31]
    v_mfma_f32_16x16x32_bf16 v[32:35], v[156:159], v[148:151], v[32:35]
    v_mfma_f32_16x16x32_bf16 v[36:39], v[156:159], v[152:155], v[36:39]
    v_mfma_f32_16x16x32_bf16 v[40:43], v[160:163], v[140:143], v[40:43]
    v_mfma_f32_16x16x32_bf16 v[44:47], v[160:163], v[144:147], v[44:47]
    v_mfma_f32_16x16x32_bf16 v[48:51], v[160:163], v[148:151], v[48:51]
    v_mfma_f32_16x16x32_bf16 v[52:55], v[160:163], v[152:155], v[52:55]
    v_mfma_f32_16x16x32_bf16 v[56:59], v[164:167], v[140:143], v[56:59]
    v_mfma_f32_16x16x32_bf16 v[60:63], v[164:167], v[144:147], v[60:63]
    v_mfma_f32_16x16x32_bf16 v[64:67], v[164:167], v[148:151], v[64:67]
    v_mfma_f32_16x16x32_bf16 v[68:71], v[164:167], v[152:155], v[68:71]
    v_mfma_f32_16x16x32_bf16 v[72:75], v[168:171], v[140:143], v[72:75]
    v_mfma_f32_16x16x32_bf16 v[76:79], v[168:171], v[144:147], v[76:79]
    v_mfma_f32_16x16x32_bf16 v[80:83], v[168:171], v[148:151], v[80:83]
    v_mfma_f32_16x16x32_bf16 v[84:87], v[168:171], v[152:155], v[84:87]
    v_mfma_f32_16x16x32_bf16 v[88:91], v[172:175], v[140:143], v[88:91]
    v_mfma_f32_16x16x32_bf16 v[92:95], v[172:175], v[144:147], v[92:95]
    v_mfma_f32_16x16x32_bf16 v[96:99], v[172:175], v[148:151], v[96:99]
    v_mfma_f32_16x16x32_bf16 v[100:103], v[172:175], v[152:155], v[100:103]
    s_waitcnt vmcnt(9)
    v_mfma_f32_16x16x32_bf16 v[24:27], v[192:195], v[176:179], v[24:27]
    v_mfma_f32_16x16x32_bf16 v[28:31], v[192:195], v[180:183], v[28:31]
    v_mfma_f32_16x16x32_bf16 v[32:35], v[192:195], v[184:187], v[32:35]
    v_mfma_f32_16x16x32_bf16 v[36:39], v[192:195], v[188:191], v[36:39]
    v_mfma_f32_16x16x32_bf16 v[40:43], v[196:199], v[176:179], v[40:43]
    v_mfma_f32_16x16x32_bf16 v[44:47], v[196:199], v[180:183], v[44:47]
    v_mfma_f32_16x16x32_bf16 v[48:51], v[196:199], v[184:187], v[48:51]
    v_mfma_f32_16x16x32_bf16 v[52:55], v[196:199], v[188:191], v[52:55]
    v_mfma_f32_16x16x32_bf16 v[56:59], v[200:203], v[176:179], v[56:59]
    v_mfma_f32_16x16x32_bf16 v[60:63], v[200:203], v[180:183], v[60:63]
    v_mfma_f32_16x16x32_bf16 v[64:67], v[200:203], v[184:187], v[64:67]
    v_mfma_f32_16x16x32_bf16 v[68:71], v[200:203], v[188:191], v[68:71]
    v_mfma_f32_16x16x32_bf16 v[72:75], v[204:207], v[176:179], v[72:75]
    v_mfma_f32_16x16x32_bf16 v[76:79], v[204:207], v[180:183], v[76:79]
    v_mfma_f32_16x16x32_bf16 v[80:83], v[204:207], v[184:187], v[80:83]
    v_mfma_f32_16x16x32_bf16 v[84:87], v[204:207], v[188:191], v[84:87]
    v_mfma_f32_16x16x32_bf16 v[88:91], v[208:211], v[176:179], v[88:91]
    v_mfma_f32_16x16x32_bf16 v[92:95], v[208:211], v[180:183], v[92:95]
    v_mfma_f32_16x16x32_bf16 v[96:99], v[208:211], v[184:187], v[96:99]
    v_mfma_f32_16x16x32_bf16 v[100:103], v[208:211], v[188:191], v[100:103]
    s_waitcnt vmcnt(0)
    v_mfma_f32_16x16x32_bf16 v[24:27], v[228:231], v[212:215], v[24:27]
    v_mfma_f32_16x16x32_bf16 v[28:31], v[228:231], v[216:219], v[28:31]
    v_mfma_f32_16x16x32_bf16 v[32:35], v[228:231], v[220:223], v[32:35]
    v_mfma_f32_16x16x32_bf16 v[36:39], v[228:231], v[224:227], v[36:39]
    v_mfma_f32_16x16x32_bf16 v[40:43], v[232:235], v[212:215], v[40:43]
    v_mfma_f32_16x16x32_bf16 v[44:47], v[232:235], v[216:219], v[44:47]
    v_mfma_f32_16x16x32_bf16 v[48:51], v[232:235], v[220:223], v[48:51]
    v_mfma_f32_16x16x32_bf16 v[52:55], v[232:235], v[224:227], v[52:55]
    v_mfma_f32_16x16x32_bf16 v[56:59], v[236:239], v[212:215], v[56:59]
    v_mfma_f32_16x16x32_bf16 v[60:63], v[236:239], v[216:219], v[60:63]
    v_mfma_f32_16x16x32_bf16 v[64:67], v[236:239], v[220:223], v[64:67]
    v_mfma_f32_16x16x32_bf16 v[68:71], v[236:239], v[224:227], v[68:71]
    v_mfma_f32_16x16x32_bf16 v[72:75], v[240:243], v[212:215], v[72:75]
    v_mfma_f32_16x16x32_bf16 v[76:79], v[240:243], v[216:219], v[76:79]
    v_mfma_f32_16x16x32_bf16 v[80:83], v[240:243], v[220:223], v[80:83]
    v_mfma_f32_16x16x32_bf16 v[84:87], v[240:243], v[224:227], v[84:87]
    v_mfma_f32_16x16x32_bf16 v[88:91], v[244:247], v[212:215], v[88:91]
    v_mfma_f32_16x16x32_bf16 v[92:95], v[244:247], v[216:219], v[92:95]
    v_mfma_f32_16x16x32_bf16 v[96:99], v[244:247], v[220:223], v[96:99]
    v_mfma_f32_16x16x32_bf16 v[100:103], v[244:247], v[224:227], v[100:103]
    buffer_load_dwordx2 v[104:105], v21, s[20:23], 0 offen offset:0
    buffer_load_dwordx2 v[106:107], v21, s[20:23], 0 offen offset:32
    buffer_load_dwordx2 v[108:109], v21, s[20:23], 0 offen offset:64
    buffer_load_dwordx2 v[10:11], v20, s[12:15], 0 offen offset:0
    buffer_load_dwordx2 v[12:13], v20, s[12:15], 0 offen offset:32
    buffer_load_dwordx2 v[14:15], v20, s[12:15], 0 offen offset:64
    s_nop 7
    s_lshl_b32 s24, s29, 11
    s_add_u32 s24, s24, 94208
    v_add_u32 v5, s24, v3
    ds_write_b128 v5, v[72:75] offset:0
    ds_write_b128 v5, v[88:91] offset:1024
    v_add_u32 v5, 17408, v5
    ds_write_b128 v5, v[76:79] offset:0
    ds_write_b128 v5, v[92:95] offset:1024
    v_add_u32 v5, 17408, v5
    ds_write_b128 v5, v[80:83] offset:0
    ds_write_b128 v5, v[96:99] offset:1024
    v_add_u32 v5, 17408, v5
    ds_write_b128 v5, v[84:87] offset:0
    ds_write_b128 v5, v[100:103] offset:1024
    s_cmp_eq_u32 s29, 0
    s_cbranch_scc1 g2skip_77
    s_sub_u32 s24, s29, 1
    s_and_b32 s24, s24, 3
    s_mul_i32 s24, s24, 3072
    s_add_u32 s24, s24, 84992
    v_add_u32 v5, s24, v3
    ds_write_b128 v5, v[24:27] offset:0
    ds_write_b128 v5, v[40:43] offset:1024
    ds_write_b128 v5, v[56:59] offset:2048
g2skip_77:
    s_cmp_eq_u32 s29, 1
    s_cbranch_scc1 g2skip_78
    s_sub_u32 s24, s29, 2
    s_and_b32 s24, s24, 3
    s_mul_i32 s24, s24, 3072
    s_add_u32 s24, s24, 102400
    v_add_u32 v5, s24, v3
    ds_write_b128 v5, v[28:31] offset:0
    ds_write_b128 v5, v[44:47] offset:1024
    ds_write_b128 v5, v[60:63] offset:2048
g2skip_78:
    s_cmp_eq_u32 s29, 2
    s_cbranch_scc1 g2skip_79
    s_sub_u32 s24, s29, 3
    s_and_b32 s24, s24, 3
    s_mul_i32 s24, s24, 3072
    s_add_u32 s24, s24, 119808
    v_add_u32 v5, s24, v3
    ds_write_b128 v5, v[32:35] offset:0
    ds_write_b128 v5, v[48:51] offset:1024
    ds_write_b128 v5, v[64:67] offset:2048
g2skip_79:
    s_cmp_eq_u32 s29, 3
    s_cbranch_scc1 g2skip_80
    s_sub_u32 s24, s29, 4
    s_and_b32 s24, s24, 3
    s_mul_i32 s24, s24, 3072
    s_add_u32 s24, s24, 137216
    v_add_u32 v5, s24, v3
    ds_write_b128 v5, v[36:39] offset:0
    ds_write_b128 v5, v[52:55] offset:1024
    ds_write_b128 v5, v[68:71] offset:2048
g2skip_80:
    s_cmp_lg_u32 s29, 0
    s_cbranch_scc1 g2own_81
    v_mov_b32 v116, v24
    v_mov_b32 v117, v25
    v_mov_b32 v118, v26
    v_mov_b32 v119, v27
    v_mov_b32 v120, v40
    v_mov_b32 v121, v41
    v_mov_b32 v122, v42
    v_mov_b32 v123, v43
    v_mov_b32 v124, v56
    v_mov_b32 v125, v57
    v_mov_b32 v126, v58
    v_mov_b32 v127, v59
g2own_81:
    s_cmp_lg_u32 s29, 1
    s_cbranch_scc1 g2own_82
    v_mov_b32 v116, v28
    v_mov_b32 v117, v29
    v_mov_b32 v118, v30
    v_mov_b32 v119, v31
    v_mov_b32 v120, v44
    v_mov_b32 v121, v45
    v_mov_b32 v122, v46
    v_mov_b32 v123, v47
    v_mov_b32 v124, v60
    v_mov_b32 v125, v61
    v_mov_b32 v126, v62
    v_mov_b32 v127, v63
g2own_82:
    s_cmp_lg_u32 s29, 2
    s_cbranch_scc1 g2own_83
    v_mov_b32 v116, v32
    v_mov_b32 v117, v33
    v_mov_b32 v118, v34
    v_mov_b32 v119, v35
    v_mov_b32 v120, v48
    v_mov_b32 v121, v49
    v_mov_b32 v122, v50
    v_mov_b32 v123, v51
    v_mov_b32 v124, v64
    v_mov_b32 v125, v65
    v_mov_b32 v126, v66
    v_mov_b32 v127, v67
g2own_83:
    s_cmp_lg_u32 s29, 3
    s_cbranch_scc1 g2own_84
    v_mov_b32 v116, v36
    v_mov_b32 v117, v37
    v_mov_b32 v118, v38
    v_mov_b32 v119, v39
    v_mov_b32 v120, v52
    v_mov_b32 v121, v53
    v_mov_b32 v122, v54
    v_mov_b32 v123, v55
    v_mov_b32 v124, v68
    v_mov_b32 v125, v69
    v_mov_b32 v126, v70
    v_mov_b32 v127, v71
g2own_84:
    s_waitcnt vmcnt(0)
    v_lshlrev_b32 v148, 16, v6
    v_mov_b32 v149, v148
    v_mov_b32 v150, v7
    v_mov_b32 v151, v7
    v_lshlrev_b32 v176, 16, v10
    v_and_b32 v177, 0xffff0000, v10
    v_lshlrev_b32 v178, 16, v11
    v_and_b32 v179, 0xffff0000, v11
    v_lshlrev_b32 v180, 16, v12
    v_and_b32 v181, 0xffff0000, v12
    v_lshlrev_b32 v182, 16, v13
    v_and_b32 v183, 0xffff0000, v13
    v_lshlrev_b32 v184, 16, v14
    v_and_b32 v185, 0xffff0000, v14
    v_lshlrev_b32 v186, 16, v15
    v_and_b32 v187, 0xffff0000, v15
    v_pk_add_f32 v[160:161], v[176:177], v[148:149] neg_lo:[0,1] neg_hi:[0,1]
    v_pk_add_f32 v[162:163], v[178:179], v[148:149] neg_lo:[0,1] neg_hi:[0,1]
    v_pk_add_f32 v[164:165], v[180:181], v[148:149] neg_lo:[0,1] neg_hi:[0,1]
    v_pk_add_f32 v[166:167], v[182:183], v[148:149] neg_lo:[0,1] neg_hi:[0,1]
    v_pk_add_f32 v[168:169], v[184:185], v[148:149] neg_lo:[0,1] neg_hi:[0,1]
    v_pk_add_f32 v[170:171], v[186:187], v[148:149] neg_lo:[0,1] neg_hi:[0,1]
    v_cvt_pk_bf16_f32 v160, 0, v160
    v_cvt_pk_bf16_f32 v161, 0, v161
    v_cvt_pk_bf16_f32 v162, 0, v162
    v_cvt_pk_bf16_f32 v163, 0, v163
    v_cvt_pk_bf16_f32 v164, 0, v164
    v_cvt_pk_bf16_f32 v165, 0, v165
    v_cvt_pk_bf16_f32 v166, 0, v166
    v_cvt_pk_bf16_f32 v167, 0, v167
    v_cvt_pk_bf16_f32 v168, 0, v168
    v_cvt_pk_bf16_f32 v169, 0, v169
    v_cvt_pk_bf16_f32 v170, 0, v170
    v_cvt_pk_bf16_f32 v171, 0, v171
    v_pk_mul_f32 v[160:161], v[160:161], v[150:151]
    v_pk_mul_f32 v[162:163], v[162:163], v[150:151]
    v_pk_mul_f32 v[164:165], v[164:165], v[150:151]
    v_pk_mul_f32 v[166:167], v[166:167], v[150:151]
    v_pk_mul_f32 v[168:169], v[168:169], v[150:151]
    v_pk_mul_f32 v[170:171], v[170:171], v[150:151]
    v_cvt_pk_bf16_f32 v160, 0, v160
    v_cvt_pk_bf16_f32 v161, 0, v161
    v_cvt_pk_bf16_f32 v162, 0, v162
    v_cvt_pk_bf16_f32 v163, 0, v163
    v_cvt_pk_bf16_f32 v164, 0, v164
    v_cvt_pk_bf16_f32 v165, 0, v165
    v_cvt_pk_bf16_f32 v166, 0, v166
    v_cvt_pk_bf16_f32 v167, 0, v167
    v_cvt_pk_bf16_f32 v168, 0, v168
    v_cvt_pk_bf16_f32 v169, 0, v169
    v_cvt_pk_bf16_f32 v170, 0, v170
    v_cvt_pk_bf16_f32 v171, 0, v171
    s_waitcnt lgkmcnt(0)
    s_barrier
    s_mul_i32 s24, s29, 17408
    s_add_u32 s24, s24, 84992
    v_add_u32 v5, s24, v3
    ds_read_b128 v[24:27], v5 offset:0
    ds_read_b128 v[28:31], v5 offset:1024
    ds_read_b128 v[32:35], v5 offset:2048
    ds_read_b128 v[36:39], v5 offset:3072
    ds_read_b128 v[40:43], v5 offset:4096
    ds_read_b128 v[44:47], v5 offset:5120
    ds_read_b128 v[48:51], v5 offset:6144
    ds_read_b128 v[52:55], v5 offset:7168
    ds_read_b128 v[56:59], v5 offset:8192
    s_mov_b32 s27, s29
    v_and_b32 v8, 15, v2
    v_lshrrev_b32 v9, 4, v2
    v_lshrrev_b32 v22, 2, v8
    v_lshl_add_u32 v22, v9, 2, v22
    v_and_b32 v8, 3, v8
    v_lshlrev_b32 v8, 3, v8
    s_lshl_b32 s24, s27, 5
    v_add_u32 v8, s24, v8
    v_add_u32 v23, 0, v22
    v_mul_u32_u24 v9, 205, v23
    v_lshrrev_b32 v9, 12, v9
    v_mul_u32_u24 v145, 20, v9
    v_sub_u32 v23, v23, v145
    v_mul_u32_u24 v9, 21248, v9
    v_lshl_add_u32 v23, v23, 7, v9
    v_add_u32 v23, v23, v8
    ds_read_b64_tr_b16 v[136:137], v23
    v_add_u32 v23, 16, v22
    v_mul_u32_u24 v9, 205, v23
    v_lshrrev_b32 v9, 12, v9
    v_mul_u32_u24 v145, 20, v9
    v_sub_u32 v23, v23, v145
    v_mul_u32_u24 v9, 21248, v9
    v_lshl_add_u32 v23, v23, 7, v9
    v_add_u32 v23, v23, v8
    ds_read_b64_tr_b16 v[138:139], v23
    v_add_u32 v23, 32, v22
    v_mul_u32_u24 v9, 205, v23
    v_lshrrev_b32 v9, 12, v9
    v_mul_u32_u24 v145, 20, v9
    v_sub_u32 v23, v23, v145
    v_mul_u32_u24 v9, 21248, v9
    v_lshl_add_u32 v23, v23, 7, v9
    v_add_u32 v23, v23, v8
    ds_read_b64_tr_b16 v[140:141], v23
    s_waitcnt vmcnt(0) lgkmcnt(0)
    v_pk_add_f32 v[116:117], v[116:117], v[24:25]
    v_pk_add_f32 v[118:119], v[118:119], v[26:27]
    v_pk_add_f32 v[120:121], v[120:121], v[28:29]
    v_pk_add_f32 v[122:123], v[122:123], v[30:31]
    v_pk_add_f32 v[124:125], v[124:125], v[32:33]
    v_pk_add_f32 v[126:127], v[126:127], v[34:35]
    v_pk_add_f32 v[116:117], v[116:117], v[36:37]
    v_pk_add_f32 v[118:119], v[118:119], v[38:39]
    v_pk_add_f32 v[120:121], v[120:121], v[40:41]
    v_pk_add_f32 v[122:123], v[122:123], v[42:43]
    v_pk_add_f32 v[124:125], v[124:125], v[44:45]
    v_pk_add_f32 v[126:127], v[126:127], v[46:47]
    v_pk_add_f32 v[116:117], v[116:117], v[48:49]
    v_pk_add_f32 v[118:119], v[118:119], v[50:51]
    v_pk_add_f32 v[120:121], v[120:121], v[52:53]
    v_pk_add_f32 v[122:123], v[122:123], v[54:55]
    v_pk_add_f32 v[124:125], v[124:125], v[56:57]
    v_pk_add_f32 v[126:127], v[126:127], v[58:59]
    s_mov_b64 s[52:53], s[94:95]
    s_and_b32 s53, s53, 0xffff
    s_mov_b32 s54, 2621440
    s_mov_b32 s55, 0x00020000
    v_mul_f32 v8, v7, v7
    v_mov_b32 v9, v8
    s_mov_b32 s24, 0xbfb8aa3b
    v_pk_mul_f32 v[116:117], v[116:117], v[8:9]
    v_pk_mul_f32 v[118:119], v[118:119], v[8:9]
    v_cvt_pk_bf16_f32 v116, 0, v116
    v_cvt_pk_bf16_f32 v117, 0, v117
    v_cvt_pk_bf16_f32 v118, 0, v118
    v_cvt_pk_bf16_f32 v119, 0, v119
    v_lshlrev_b32 v26, 16, v104
    v_and_b32 v27, 0xffff0000, v104
    v_lshlrev_b32 v38, 16, v105
    v_and_b32 v39, 0xffff0000, v105
    v_pk_add_f32 v[116:117], v[116:117], v[26:27]
    v_pk_add_f32 v[118:119], v[118:119], v[38:39]
    v_cvt_pk_bf16_f32 v116, 0, v116
    v_cvt_pk_bf16_f32 v117, 0, v117
    v_cvt_pk_bf16_f32 v118, 0, v118
    v_cvt_pk_bf16_f32 v119, 0, v119
    v_mul_f32 v26, s24, v116
    v_mul_f32 v27, s24, v117
    v_mul_f32 v38, s24, v118
    v_mul_f32 v39, s24, v119
    v_exp_f32 v26, v26
    v_exp_f32 v27, v27
    v_exp_f32 v38, v38
    v_exp_f32 v39, v39
    v_lshlrev_b32 v32, 16, v136
    v_and_b32 v33, 0xffff0000, v136
    v_lshlrev_b32 v44, 16, v137
    v_and_b32 v45, 0xffff0000, v137
    v_add_f32 v26, 1.0, v26
    v_add_f32 v27, 1.0, v27
    v_add_f32 v38, 1.0, v38
    v_add_f32 v39, 1.0, v39
    v_rcp_f32 v26, v26
    v_rcp_f32 v27, v27
    v_rcp_f32 v38, v38
    v_rcp_f32 v39, v39
    v_pk_mul_f32 v[30:31], v[160:161], v[32:33]
    v_pk_mul_f32 v[42:43], v[162:163], v[44:45]
    v_pk_mul_f32 v[116:117], v[116:117], v[26:27]
    v_pk_mul_f32 v[118:119], v[118:119], v[38:39]
    v_cvt_pk_bf16_f32 v30, 0, v30
    v_cvt_pk_bf16_f32 v31, 0, v31
    v_cvt_pk_bf16_f32 v42, 0, v42
    v_cvt_pk_bf16_f32 v43, 0, v43
    v_cvt_pk_bf16_f32 v116, 0, v116
    v_cvt_pk_bf16_f32 v117, 0, v117
    v_cvt_pk_bf16_f32 v118, 0, v118
    v_cvt_pk_bf16_f32 v119, 0, v119
    v_pk_mul_f32 v[30:31], v[30:31], v[116:117]
    v_pk_mul_f32 v[42:43], v[42:43], v[118:119]
    v_cvt_pk_bf16_f32 v30, 0, v30
    v_cvt_pk_bf16_f32 v31, 0, v31
    v_cvt_pk_bf16_f32 v42, 0, v42
    v_cvt_pk_bf16_f32 v43, 0, v43
    v_pk_add_f32 v[30:31], v[30:31], v[176:177]
    v_pk_add_f32 v[42:43], v[42:43], v[178:179]
    v_cvt_pk_bf16_f32 v152, v30, v31
    v_cvt_pk_bf16_f32 v153, v42, v43
    buffer_store_dwordx2 v[152:153], v20, s[52:55], 0 offen offset:0
    v_pk_mul_f32 v[120:121], v[120:121], v[8:9]
    v_pk_mul_f32 v[122:123], v[122:123], v[8:9]
    v_cvt_pk_bf16_f32 v120, 0, v120
    v_cvt_pk_bf16_f32 v121, 0, v121
    v_cvt_pk_bf16_f32 v122, 0, v122
    v_cvt_pk_bf16_f32 v123, 0, v123
    v_lshlrev_b32 v26, 16, v106
    v_and_b32 v27, 0xffff0000, v106
    v_lshlrev_b32 v38, 16, v107
    v_and_b32 v39, 0xffff0000, v107
    v_pk_add_f32 v[120:121], v[120:121], v[26:27]
    v_pk_add_f32 v[122:123], v[122:123], v[38:39]
    v_cvt_pk_bf16_f32 v120, 0, v120
    v_cvt_pk_bf16_f32 v121, 0, v121
    v_cvt_pk_bf16_f32 v122, 0, v122
    v_cvt_pk_bf16_f32 v123, 0, v123
    v_mul_f32 v26, s24, v120
    v_mul_f32 v27, s24, v121
    v_mul_f32 v38, s24, v122
    v_mul_f32 v39, s24, v123
    v_exp_f32 v26, v26
    v_exp_f32 v27, v27
    v_exp_f32 v38, v38
    v_exp_f32 v39, v39
    v_lshlrev_b32 v32, 16, v138
    v_and_b32 v33, 0xffff0000, v138
    v_lshlrev_b32 v44, 16, v139
    v_and_b32 v45, 0xffff0000, v139
    v_add_f32 v26, 1.0, v26
    v_add_f32 v27, 1.0, v27
    v_add_f32 v38, 1.0, v38
    v_add_f32 v39, 1.0, v39
    v_rcp_f32 v26, v26
    v_rcp_f32 v27, v27
    v_rcp_f32 v38, v38
    v_rcp_f32 v39, v39
    v_pk_mul_f32 v[30:31], v[164:165], v[32:33]
    v_pk_mul_f32 v[42:43], v[166:167], v[44:45]
    v_pk_mul_f32 v[120:121], v[120:121], v[26:27]
    v_pk_mul_f32 v[122:123], v[122:123], v[38:39]
    v_cvt_pk_bf16_f32 v30, 0, v30
    v_cvt_pk_bf16_f32 v31, 0, v31
    v_cvt_pk_bf16_f32 v42, 0, v42
    v_cvt_pk_bf16_f32 v43, 0, v43
    v_cvt_pk_bf16_f32 v120, 0, v120
    v_cvt_pk_bf16_f32 v121, 0, v121
    v_cvt_pk_bf16_f32 v122, 0, v122
    v_cvt_pk_bf16_f32 v123, 0, v123
    v_pk_mul_f32 v[30:31], v[30:31], v[120:121]
    v_pk_mul_f32 v[42:43], v[42:43], v[122:123]
    v_cvt_pk_bf16_f32 v30, 0, v30
    v_cvt_pk_bf16_f32 v31, 0, v31
    v_cvt_pk_bf16_f32 v42, 0, v42
    v_cvt_pk_bf16_f32 v43, 0, v43
    v_pk_add_f32 v[30:31], v[30:31], v[180:181]
    v_pk_add_f32 v[42:43], v[42:43], v[182:183]
    v_cvt_pk_bf16_f32 v154, v30, v31
    v_cvt_pk_bf16_f32 v155, v42, v43
    buffer_store_dwordx2 v[154:155], v20, s[52:55], 0 offen offset:32
    v_pk_mul_f32 v[124:125], v[124:125], v[8:9]
    v_pk_mul_f32 v[126:127], v[126:127], v[8:9]
    v_cvt_pk_bf16_f32 v124, 0, v124
    v_cvt_pk_bf16_f32 v125, 0, v125
    v_cvt_pk_bf16_f32 v126, 0, v126
    v_cvt_pk_bf16_f32 v127, 0, v127
    v_lshlrev_b32 v26, 16, v108
    v_and_b32 v27, 0xffff0000, v108
    v_lshlrev_b32 v38, 16, v109
    v_and_b32 v39, 0xffff0000, v109
    v_pk_add_f32 v[124:125], v[124:125], v[26:27]
    v_pk_add_f32 v[126:127], v[126:127], v[38:39]
    v_cvt_pk_bf16_f32 v124, 0, v124
    v_cvt_pk_bf16_f32 v125, 0, v125
    v_cvt_pk_bf16_f32 v126, 0, v126
    v_cvt_pk_bf16_f32 v127, 0, v127
    v_mul_f32 v26, s24, v124
    v_mul_f32 v27, s24, v125
    v_mul_f32 v38, s24, v126
    v_mul_f32 v39, s24, v127
    v_exp_f32 v26, v26
    v_exp_f32 v27, v27
    v_exp_f32 v38, v38
    v_exp_f32 v39, v39
    v_lshlrev_b32 v32, 16, v140
    v_and_b32 v33, 0xffff0000, v140
    v_lshlrev_b32 v44, 16, v141
    v_and_b32 v45, 0xffff0000, v141
    v_add_f32 v26, 1.0, v26
    v_add_f32 v27, 1.0, v27
    v_add_f32 v38, 1.0, v38
    v_add_f32 v39, 1.0, v39
    v_rcp_f32 v26, v26
    v_rcp_f32 v27, v27
    v_rcp_f32 v38, v38
    v_rcp_f32 v39, v39
    v_pk_mul_f32 v[30:31], v[168:169], v[32:33]
    v_pk_mul_f32 v[42:43], v[170:171], v[44:45]
    v_pk_mul_f32 v[124:125], v[124:125], v[26:27]
    v_pk_mul_f32 v[126:127], v[126:127], v[38:39]
    v_cvt_pk_bf16_f32 v30, 0, v30
    v_cvt_pk_bf16_f32 v31, 0, v31
    v_cvt_pk_bf16_f32 v42, 0, v42
    v_cvt_pk_bf16_f32 v43, 0, v43
    v_cvt_pk_bf16_f32 v124, 0, v124
    v_cvt_pk_bf16_f32 v125, 0, v125
    v_cvt_pk_bf16_f32 v126, 0, v126
    v_cvt_pk_bf16_f32 v127, 0, v127
    v_pk_mul_f32 v[30:31], v[30:31], v[124:125]
    v_pk_mul_f32 v[42:43], v[42:43], v[126:127]
    v_cvt_pk_bf16_f32 v30, 0, v30
    v_cvt_pk_bf16_f32 v31, 0, v31
    v_cvt_pk_bf16_f32 v42, 0, v42
    v_cvt_pk_bf16_f32 v43, 0, v43
    v_pk_add_f32 v[30:31], v[30:31], v[184:185]
    v_pk_add_f32 v[42:43], v[42:43], v[186:187]
    v_cvt_pk_bf16_f32 v156, v30, v31
    v_cvt_pk_bf16_f32 v157, v42, v43
    buffer_store_dwordx2 v[156:157], v20, s[52:55], 0 offen offset:64
recurrent_scan__ssm_conv_h3__dense_activation_squared_relu__prompt_kernel_end:
    s_endpgm
.section .rodata,"a"
.p2align 6
.amdhsa_kernel recurrent_scan__ssm_conv_h3__dense_activation_squared_relu__prompt_kernel
  .amdhsa_next_free_vgpr 256
  .amdhsa_next_free_sgpr 102
  .amdhsa_accum_offset 256
  .amdhsa_group_segment_fixed_size 0
  .amdhsa_kernarg_size 112
  .amdhsa_user_sgpr_count 2
  .amdhsa_user_sgpr_kernarg_segment_ptr 1
  .amdhsa_system_sgpr_workgroup_id_x 1
  .amdhsa_float_denorm_mode_32 3
.end_amdhsa_kernel
```
